```python
import torch

def _softmax(x, axis=-1):
    return torch.softmax(x, dim=axis)
def _gelu(x):
    return torch.nn.functional.gelu(x, approximate="tanh")
def _silu(x):
    return torch.nn.functional.silu(x)
def _sigmoid(x):
    return torch.sigmoid(x)
def _layernorm(x, axis=-1, eps=1e-5):
    m = x.mean(dim=axis, keepdim=True)
    v = x.var(dim=axis, keepdim=True, unbiased=False)
    return (x - m) / torch.sqrt(v + eps)
def _scatter_add(tgt, idx, src, axis=0):
    return tgt.clone().index_add_(axis, idx, src)
def _segment_sum(src, seg, n):
    out = torch.zeros((n,) + src.shape[1:], dtype=src.dtype)
    return out.index_add_(0, seg, src)
def _pad(x, pw):
    flat = tuple(v for pair in reversed(pw) for v in pair)
    return torch.nn.functional.pad(x, flat)

kernel_name = 'standalone__mha_block_cached__near_ridge'

def setup_inputs():

    _w = (lambda a: (lambda t: t.to(torch.bfloat16) if t.is_floating_point() else t)(torch.as_tensor(a)))
    B, Sq, D = 8, 224, 576
    H, Sk, Dh = 32, 512, 128
    return {
        "x": _w((lambda *s: torch.randn(*s, dtype=torch.bfloat16) * 0.8)(B, Sq, D)),
        "k_cache": _w((lambda *s: torch.randn(*s, dtype=torch.bfloat16) * 0.8)(B, H, Sk, Dh)),
        "v_cache": _w((lambda *s: torch.randn(*s, dtype=torch.bfloat16) * 0.05)(B, H, Sk, Dh)),
        "wq": _w((lambda *s: torch.randn(*s, dtype=torch.bfloat16) * 0.8)(D, H * Dh) * (D ** -0.5)),
        "wo": _w((lambda *s: torch.randn(*s, dtype=torch.bfloat16) * 0.05)(H * Dh, D) * ((H * Dh) ** -0.5)),
    }

def reference(x, k_cache, v_cache, wq, wo):
    B, Sq, D = x.shape
    H, Dh = 32, 128
    q = (lambda x, *d: x.permute(*d))((x @ wq).reshape(B, Sq, H, Dh), 0, 2, 1, 3)
    scores = torch.einsum("bhqd,bhkd->bhqk", q, k_cache) * (Dh ** -0.5)
    p = _softmax(scores, axis=-1)
    o = torch.einsum("bhqk,bhkd->bhqd", p, v_cache)
    return (lambda x, *d: x.permute(*d))(o, 0, 2, 1, 3).reshape(B, Sq, H * Dh) @ wo
```

```asm
; @launch grid=(256,1,1) block=(512,1,1) lds=163840
.amdgcn_target "amdgcn-amd-amdhsa--gfx950"
.text
.globl standalone__mha_block_cached__near_ridge_kernel
.p2align 8
.type standalone__mha_block_cached__near_ridge_kernel,@function
standalone__mha_block_cached__near_ridge_kernel:
    s_cmp_ge_u32 s2, 256
    s_cbranch_scc1 L_END
    s_load_dwordx16 s[16:31], s[0:1], 0
    v_lshrrev_b32 v1, 6, v0
    v_and_b32 v0, 63, v0
    v_readfirstlane_b32 s3, v1
    s_mov_b32 s84, 0
    s_cmp_lg_u32 s3, 6
    s_cbranch_scc1 L_NOCPF
    s_getpc_b64 s[4:5]
L_PC:
    s_sub_u32 s4, s4, L_PC-standalone__mha_block_cached__near_ridge_kernel
    s_subb_u32 s5, s5, 0
    s_lshr_b32 s6, s2, 3
    s_lshl_b32 s6, s6, 10
    v_lshlrev_b32 v2, 4, v0
    v_add_u32 v2, s6, v2
    v_min_u32 v2, L_CODE_END-standalone__mha_block_cached__near_ridge_kernel-16, v2
    v_mov_b32 v3, s5
    v_add_co_u32 v2, vcc, s4, v2
    s_nop 1
    v_addc_co_u32 v3, vcc, 0, v3, vcc
    global_load_dwordx4 v[40:43], v[2:3], off
L_NOCPF:
    s_and_b32 s92, s2, 7
    s_lshr_b32 s94, s2, 3
    s_and_b32 s6, s2, 1
    s_lshr_b32 s7, s94, 3
    s_lshl_b32 s4, s6, 2
    s_add_u32 s8, s4, s7
    s_lshr_b32 s93, s92, 1
    s_and_b32 s5, s94, 7
    s_lshl_b32 s4, s93, 3
    s_add_u32 s9, s4, s5
    s_add_u32 s4, s5, s7
    s_mul_i32 s13, s4, 86
    s_lshr_b32 s13, s13, 8
    s_mul_i32 s13, s13, 3
    s_sub_u32 s4, s4, s13
    s_mul_i32 s11, s4, 3
    s_add_u32 s4, s93, s6
    s_sub_u32 s13, s4, 3
    s_cmp_ge_u32 s4, 3
    s_cselect_b32 s4, s13, s4
    s_add_u32 s11, s11, s4
    s_lshl_b32 s95, s6, 5
    s_add_u32 s95, s95, s94
    s_and_b32 s4, s94, 0xfc
    s_sub_u32 s5, s94, 28
    s_mul_i32 s5, s5, 7
    s_and_b32 s7, s94, 3
    s_lshl_b32 s7, s7, 8
    s_cmp_ge_u32 s94, 28
    s_cselect_b32 s96, s5, s4
    s_cselect_b32 s97, 1024, s7
    v_and_b32 v2, 3, v0
    v_bfe_u32 v3, v0, 2, 2
    v_lshrrev_b32 v4, 4, v0
    v_lshrrev_b32 v5, 5, v0
    v_and_b32 v6, 31, v0
    v_lshlrev_b32 v36, 4, v0
    v_lshlrev_b32 v37, 2, v0
    v_add_u32 v32, 90112, v37
    s_add_u32 s4, s3, 1
    s_and_b32 s4, s4, 7
    s_lshl_b32 s4, s4, 8
    v_add_u32 v33, s4, v32
    s_sub_u32 s4, s3, 4
    s_cmp_lt_u32 s4, 3
    s_cselect_b32 s4, 9, 0
    v_mov_b32 v35, s4
    ds_write_b32 v33, v35
    v_mov_b32 v7, 0
    ds_write_b32 v32, v7 offset:2048
    s_waitcnt lgkmcnt(0)
    s_mov_b32 s32, s16
    s_mov_b32 s33, s17
    s_mov_b32 s34, 2064384
    s_mov_b32 s35, 0x00020000
    s_mov_b32 s40, s18
    s_mov_b32 s41, s19
    s_mov_b32 s42, 33554432
    s_mov_b32 s43, 0x00020000
    s_mov_b32 s44, s20
    s_mov_b32 s45, s21
    s_mov_b32 s46, 33554432
    s_mov_b32 s47, 0x00020000
    s_mov_b32 s36, s22
    s_mov_b32 s37, s23
    s_mov_b32 s38, 4718592
    s_mov_b32 s39, 0x00020000
    s_mov_b32 s52, s24
    s_mov_b32 s53, s25
    s_mov_b32 s54, 4718592
    s_mov_b32 s55, 0x00020000
    s_mov_b32 s56, s26
    s_mov_b32 s57, s27
    s_mov_b32 s58, 2064384
    s_mov_b32 s59, 0x00020000
    s_mov_b32 s60, s28
    s_mov_b32 s61, s29
    s_mov_b32 s62, 256
    s_mov_b32 s63, 0x00020000
    s_mov_b32 s48, s30
    s_mov_b32 s49, s31
    s_mov_b32 s50, 67108864
    s_mov_b32 s51, 0x00020000
    s_lshl_b32 s15, s2, 8
    s_add_u32 s15, s15, 33554432
    s_cmp_eq_u32 s3, 7
    s_cbranch_scc1 L_LOADER
    v_add_u32 v7, 1, v0
    v_lshlrev_b32 v7, 8, v7
    v_add_u32 v7, 90112, v7
    v_cmp_gt_u32 vcc, 7, v0
    s_nop 1
    v_cndmask_b32 v32, v32, v7, vcc
    v_cndmask_b32 v28, 0, 1, vcc
    v_mul_u32_u24 v7, 64, v28
    v_sub_u32 v27, 1, v7
    v_and_b32 v29, 1, v4
    v_lshlrev_b32 v7, 10, v5
    v_lshl_add_u32 v7, v3, 6, v7
    v_lshl_add_u32 v7, v29, 5, v7
    v_lshl_add_u32 v18, v2, 3, v7
    v_lshrrev_b32 v7, 2, v6
    v_lshlrev_b32 v7, 10, v7
    v_lshl_add_u32 v7, v2, 6, v7
    v_xor_b32 v16, v5, v3
    v_lshl_add_u32 v16, v16, 4, v7
    v_xor_b32 v17, 32, v16
    v_mov_b32 v34, 0
    s_cmp_ge_u32 s3, 4
    s_cbranch_scc1 L_QWAIT
    v_lshrrev_b32 v7, 3, v6
    v_lshlrev_b32 v7, 10, v7
    v_and_b32 v30, 1, v3
    v_lshl_add_u32 v7, v30, 8, v7
    v_lshl_add_u32 v7, v2, 6, v7
    v_xor_b32 v14, v5, v3
    v_lshl_add_u32 v14, v14, 4, v7
    s_lshl_b32 s4, s3, 12
    v_add_u32 v14, s4, v14
    v_xor_b32 v15, 32, v14
    v_lshlrev_b32 v7, 11, v5
    v_lshl_add_u32 v7, v3, 6, v7
    v_lshl_add_u32 v7, v29, 5, v7
    v_and_b32 v30, 1, v2
    v_lshl_add_u32 v12, v30, 4, v7
    v_lshrrev_b32 v30, 1, v2
    v_lshl_add_u32 v12, v30, 3, v12
    s_mov_b32 s10, 0
    s_mov_b32 s85, 1
    s_mov_b32 s86, 126976
    s_mov_b32 s89, 16384
    s_mov_b32 s87, 32768
    s_mov_b32 s90, 110592
    s_mov_b32 s88, 61440
    s_mov_b32 s91, 94208
    v_mov_b32 v192, 0
    v_mov_b32 v193, 0
    v_mov_b32 v194, 0
    v_mov_b32 v195, 0
    v_mov_b32 v196, 0
    v_mov_b32 v197, 0
    v_mov_b32 v198, 0
    v_mov_b32 v199, 0
    v_mov_b32 v200, 0
    v_mov_b32 v201, 0
    v_mov_b32 v202, 0
    v_mov_b32 v203, 0
    v_mov_b32 v204, 0
    v_mov_b32 v205, 0
    v_mov_b32 v206, 0
    v_mov_b32 v207, 0
    v_mov_b32 v208, 0
    v_mov_b32 v209, 0
    v_mov_b32 v210, 0
    v_mov_b32 v211, 0
    v_mov_b32 v212, 0
    v_mov_b32 v213, 0
    v_mov_b32 v214, 0
    v_mov_b32 v215, 0
    v_mov_b32 v216, 0
    v_mov_b32 v217, 0
    v_mov_b32 v218, 0
    v_mov_b32 v219, 0
    v_mov_b32 v220, 0
    v_mov_b32 v221, 0
    v_mov_b32 v222, 0
    v_mov_b32 v223, 0
    v_mov_b32 v224, 0
    v_mov_b32 v225, 0
    v_mov_b32 v226, 0
    v_mov_b32 v227, 0
    v_mov_b32 v228, 0
    v_mov_b32 v229, 0
    v_mov_b32 v230, 0
    v_mov_b32 v231, 0
    v_mov_b32 v232, 0
    v_mov_b32 v233, 0
    v_mov_b32 v234, 0
    v_mov_b32 v235, 0
    v_mov_b32 v236, 0
    v_mov_b32 v237, 0
    v_mov_b32 v238, 0
    v_mov_b32 v239, 0
    v_mov_b32 v240, 0
    v_mov_b32 v241, 0
    v_mov_b32 v242, 0
    v_mov_b32 v243, 0
    v_mov_b32 v244, 0
    v_mov_b32 v245, 0
    v_mov_b32 v246, 0
    v_mov_b32 v247, 0
    v_mov_b32 v248, 0
    v_mov_b32 v249, 0
    v_mov_b32 v250, 0
    v_mov_b32 v251, 0
    v_mov_b32 v252, 0
    v_mov_b32 v253, 0
    v_mov_b32 v254, 0
    v_mov_b32 v255, 0
    v_mov_b32 v144, 0
    v_mov_b32 v145, 0
    v_mov_b32 v146, 0
    v_mov_b32 v147, 0
    v_mov_b32 v148, 0
    v_mov_b32 v149, 0
    v_mov_b32 v150, 0
    v_mov_b32 v151, 0
    v_mov_b32 v152, 0
    v_mov_b32 v153, 0
    v_mov_b32 v154, 0
    v_mov_b32 v155, 0
    v_mov_b32 v156, 0
    v_mov_b32 v157, 0
    v_mov_b32 v158, 0
    v_mov_b32 v159, 0
    v_mov_b32 v160, 0
    v_mov_b32 v161, 0
    v_mov_b32 v162, 0
    v_mov_b32 v163, 0
    v_mov_b32 v164, 0
    v_mov_b32 v165, 0
    v_mov_b32 v166, 0
    v_mov_b32 v167, 0
    v_mov_b32 v168, 0
    v_mov_b32 v169, 0
    v_mov_b32 v170, 0
    v_mov_b32 v171, 0
    v_mov_b32 v172, 0
    v_mov_b32 v173, 0
    v_mov_b32 v174, 0
    v_mov_b32 v175, 0
    v_mov_b32 v176, 0
    v_mov_b32 v177, 0
    v_mov_b32 v178, 0
    v_mov_b32 v179, 0
    v_mov_b32 v180, 0
    v_mov_b32 v181, 0
    v_mov_b32 v182, 0
    v_mov_b32 v183, 0
    v_mov_b32 v184, 0
    v_mov_b32 v185, 0
    v_mov_b32 v186, 0
    v_mov_b32 v187, 0
    v_mov_b32 v188, 0
    v_mov_b32 v189, 0
    v_mov_b32 v190, 0
    v_mov_b32 v191, 0
    v_mov_b32 v56, 0
    v_mov_b32 v57, 0
    v_mov_b32 v58, 0
    v_mov_b32 v59, 0
    v_mov_b32 v60, 0
    v_mov_b32 v61, 0
    v_mov_b32 v62, 0
    v_mov_b32 v63, 0
    v_mov_b32 v64, 0
    v_mov_b32 v65, 0
    v_mov_b32 v66, 0
    v_mov_b32 v67, 0
    v_mov_b32 v68, 0
    v_mov_b32 v69, 0
    v_mov_b32 v70, 0
    v_mov_b32 v71, 0
    v_mov_b32 v88, 0
    v_mov_b32 v89, 0
    v_mov_b32 v90, 0
    v_mov_b32 v91, 0
    v_mov_b32 v92, 0
    v_mov_b32 v93, 0
    v_mov_b32 v94, 0
    v_mov_b32 v95, 0
    v_mov_b32 v96, 0
    v_mov_b32 v97, 0
    v_mov_b32 v98, 0
    v_mov_b32 v99, 0
    v_mov_b32 v100, 0
    v_mov_b32 v101, 0
    v_mov_b32 v102, 0
    v_mov_b32 v103, 0
    s_lshl_b32 s4, s3, 13
    s_cmp_eq_u32 s3, 3
    s_cselect_b32 s4, 6144, s4
    s_cselect_b32 s5, 4, 1
    s_lshl_b32 s5, s5, 11
    s_add_u32 s4, s4, 57344
    v_add_u32 v29, s4, v36
    v_add_u32 v30, s5, v29
    v_add_u32 v31, s5, v30
    s_barrier
    s_cmp_eq_u32 s3, 3
    s_cbranch_scc1 L_QLOOPB
L_QLOOPA:
    v_add_u32 v13, s89, v12
    v_add_u32 v10, s86, v14
    v_add_u32 v11, s86, v15
    v_cmp_gt_i32 vcc, v27, v34
    s_cbranch_vccnz L_SPIN1
L_SRET2:
    v_mfma_f32_32x32x16_bf16 v[192:207], v[56:59], v[88:91], v[192:207]
    ds_read_b128 v[72:75], v10 offset:0
    ds_read_b64_tr_b16 v[40:41], v13 offset:0
    v_mfma_f32_32x32x16_bf16 v[144:159], v[56:59], v[92:95], v[144:159]
    ds_read_b64_tr_b16 v[42:43], v13 offset:1024
    ds_read_b128 v[76:79], v10 offset:16384
    v_mfma_f32_32x32x16_bf16 v[208:223], v[60:63], v[88:91], v[208:223]
    ds_read_b64_tr_b16 v[44:45], v13 offset:256
    ds_read_b64_tr_b16 v[46:47], v13 offset:1280
    v_mfma_f32_32x32x16_bf16 v[160:175], v[60:63], v[92:95], v[160:175]
    ds_read_b64_tr_b16 v[48:49], v13 offset:512
    ds_read_b64_tr_b16 v[50:51], v13 offset:1536
    v_mfma_f32_32x32x16_bf16 v[224:239], v[64:67], v[88:91], v[224:239]
    ds_read_b64_tr_b16 v[52:53], v13 offset:768
    ds_read_b64_tr_b16 v[54:55], v13 offset:1792
    v_mfma_f32_32x32x16_bf16 v[176:191], v[64:67], v[92:95], v[176:191]
    v_mfma_f32_32x32x16_bf16 v[240:255], v[68:71], v[88:91], v[240:255]
    s_waitcnt lgkmcnt(7)
    v_mfma_f32_32x32x16_bf16 v[192:207], v[40:43], v[72:75], v[192:207]
    ds_read_b128 v[88:91], v11 offset:0
    ds_read_b64_tr_b16 v[56:57], v13 offset:4096
    s_waitcnt lgkmcnt(8)
    v_mfma_f32_32x32x16_bf16 v[144:159], v[40:43], v[76:79], v[144:159]
    ds_read_b64_tr_b16 v[58:59], v13 offset:5120
    ds_read_b128 v[92:95], v11 offset:16384
    s_waitcnt lgkmcnt(8)
    v_mfma_f32_32x32x16_bf16 v[208:223], v[44:47], v[72:75], v[208:223]
    ds_read_b64_tr_b16 v[60:61], v13 offset:4352
    ds_read_b64_tr_b16 v[62:63], v13 offset:5376
    v_mfma_f32_32x32x16_bf16 v[160:175], v[44:47], v[76:79], v[160:175]
    ds_read_b64_tr_b16 v[64:65], v13 offset:4608
    ds_read_b64_tr_b16 v[66:67], v13 offset:5632
    s_waitcnt lgkmcnt(10)
    v_mfma_f32_32x32x16_bf16 v[224:239], v[48:51], v[72:75], v[224:239]
    ds_read_b64_tr_b16 v[68:69], v13 offset:4864
    ds_read_b64_tr_b16 v[70:71], v13 offset:5888
    v_mfma_f32_32x32x16_bf16 v[176:191], v[48:51], v[76:79], v[176:191]
    s_waitcnt lgkmcnt(10)
    v_mfma_f32_32x32x16_bf16 v[240:255], v[52:55], v[72:75], v[240:255]
    s_waitcnt lgkmcnt(7)
    v_mfma_f32_32x32x16_bf16 v[192:207], v[56:59], v[88:91], v[192:207]
    ds_read_b128 v[72:75], v10 offset:512
    ds_read_b64_tr_b16 v[40:41], v13 offset:8192
    s_waitcnt lgkmcnt(8)
    v_mfma_f32_32x32x16_bf16 v[144:159], v[56:59], v[92:95], v[144:159]
    ds_read_b64_tr_b16 v[42:43], v13 offset:9216
    ds_read_b128 v[76:79], v10 offset:16896
    s_waitcnt lgkmcnt(8)
    v_mfma_f32_32x32x16_bf16 v[208:223], v[60:63], v[88:91], v[208:223]
    ds_read_b64_tr_b16 v[44:45], v13 offset:8448
    ds_read_b64_tr_b16 v[46:47], v13 offset:9472
    v_mfma_f32_32x32x16_bf16 v[160:175], v[60:63], v[92:95], v[160:175]
    ds_read_b64_tr_b16 v[48:49], v13 offset:8704
    ds_read_b64_tr_b16 v[50:51], v13 offset:9728
    s_waitcnt lgkmcnt(10)
    v_mfma_f32_32x32x16_bf16 v[224:239], v[64:67], v[88:91], v[224:239]
    ds_read_b64_tr_b16 v[52:53], v13 offset:8960
    ds_read_b64_tr_b16 v[54:55], v13 offset:9984
    v_mfma_f32_32x32x16_bf16 v[176:191], v[64:67], v[92:95], v[176:191]
    s_mov_b32 s4, s86
    s_mov_b32 s86, s87
    s_waitcnt lgkmcnt(10)
    v_mfma_f32_32x32x16_bf16 v[240:255], v[68:71], v[88:91], v[240:255]
    s_mov_b32 s87, s88
    s_mov_b32 s88, s4
    s_waitcnt lgkmcnt(7)
    v_mfma_f32_32x32x16_bf16 v[192:207], v[40:43], v[72:75], v[192:207]
    ds_read_b128 v[88:91], v11 offset:512
    ds_read_b64_tr_b16 v[56:57], v13 offset:12288
    ds_read_b64_tr_b16 v[58:59], v13 offset:13312
    s_waitcnt lgkmcnt(9)
    v_mfma_f32_32x32x16_bf16 v[144:159], v[40:43], v[76:79], v[144:159]
    ds_read_b128 v[92:95], v11 offset:16896
    ds_read_b64_tr_b16 v[60:61], v13 offset:12544
    ds_read_b64_tr_b16 v[62:63], v13 offset:13568
    s_waitcnt lgkmcnt(10)
    v_mfma_f32_32x32x16_bf16 v[208:223], v[44:47], v[72:75], v[208:223]
    ds_read_b64_tr_b16 v[64:65], v13 offset:12800
    ds_read_b64_tr_b16 v[66:67], v13 offset:13824
    ds_read_b64_tr_b16 v[68:69], v13 offset:13056
    v_mfma_f32_32x32x16_bf16 v[160:175], v[44:47], v[76:79], v[160:175]
    ds_read_b64_tr_b16 v[70:71], v13 offset:14080
    ds_read_b32 v34, v32
    v_mov_b32 v35, s85
    s_waitcnt lgkmcnt(13)
    v_mfma_f32_32x32x16_bf16 v[224:239], v[48:51], v[72:75], v[224:239]
    s_add_u32 s85, s85, 1
    v_add_u32 v27, 1, v27
    s_mov_b32 s4, s89
    s_mov_b32 s89, s90
    s_mov_b32 s90, s91
    s_mov_b32 s91, s4
    s_add_u32 s10, s10, 1
    s_cmp_gt_u32 s10, 6
    v_mfma_f32_32x32x16_bf16 v[176:191], v[48:51], v[76:79], v[176:191]
    s_waitcnt lgkmcnt(0)
    s_cbranch_scc1 L_QRELA
    s_barrier
    v_mfma_f32_32x32x16_bf16 v[240:255], v[52:55], v[72:75], v[240:255]
    s_branch L_QLOOPA
L_QRELA:
    ds_write_b32 v33, v35
    s_cmp_lt_u32 s10, 9
    v_mfma_f32_32x32x16_bf16 v[240:255], v[52:55], v[72:75], v[240:255]
    s_cbranch_scc1 L_QLOOPA
    v_mfma_f32_32x32x16_bf16 v[144:159], v[56:59], v[92:95], v[144:159]
    v_mfma_f32_32x32x16_bf16 v[160:175], v[60:63], v[92:95], v[160:175]
    v_mfma_f32_32x32x16_bf16 v[176:191], v[64:67], v[92:95], v[176:191]
    v_mfma_f32_32x32x16_bf16 v[192:207], v[56:59], v[88:91], v[192:207]
    v_mfma_f32_32x32x16_bf16 v[208:223], v[60:63], v[88:91], v[208:223]
    v_mfma_f32_32x32x16_bf16 v[224:239], v[64:67], v[88:91], v[224:239]
    v_mfma_f32_32x32x16_bf16 v[240:255], v[68:71], v[88:91], v[240:255]
    s_branch L_QDONE
L_QLOOPB:
    v_add_u32 v13, s89, v12
    v_add_u32 v10, s86, v14
    v_add_u32 v11, s86, v15
    v_cmp_gt_i32 vcc, v27, v34
    s_cbranch_vccnz L_SPIN3
L_SRET4:
    v_mfma_f32_32x32x16_bf16 v[192:207], v[56:59], v[88:91], v[192:207]
    ds_read_b128 v[72:75], v10 offset:0
    ds_read_b64_tr_b16 v[40:41], v13 offset:0
    v_mfma_f32_32x32x16_bf16 v[208:223], v[60:63], v[88:91], v[208:223]
    ds_read_b64_tr_b16 v[42:43], v13 offset:1024
    ds_read_b128 v[76:79], v10 offset:4096
    v_mfma_f32_32x32x16_bf16 v[224:239], v[64:67], v[88:91], v[224:239]
    ds_read_b64_tr_b16 v[44:45], v13 offset:256
    ds_read_b64_tr_b16 v[46:47], v13 offset:1280
    v_mfma_f32_32x32x16_bf16 v[240:255], v[68:71], v[88:91], v[240:255]
    ds_read_b64_tr_b16 v[48:49], v13 offset:512
    ds_read_b64_tr_b16 v[50:51], v13 offset:1536
    v_mfma_f32_32x32x16_bf16 v[144:159], v[68:71], v[92:95], v[144:159]
    ds_read_b64_tr_b16 v[52:53], v13 offset:768
    ds_read_b64_tr_b16 v[54:55], v13 offset:1792
    v_mfma_f32_32x32x16_bf16 v[160:175], v[68:71], v[96:99], v[160:175]
    ds_read_b128 v[80:83], v10 offset:8192
    ds_read_b128 v[84:87], v10 offset:12288
    v_mfma_f32_32x32x16_bf16 v[176:191], v[68:71], v[100:103], v[176:191]
    s_waitcnt lgkmcnt(9)
    v_mfma_f32_32x32x16_bf16 v[192:207], v[40:43], v[72:75], v[192:207]
    ds_read_b128 v[88:91], v11 offset:0
    ds_read_b64_tr_b16 v[56:57], v13 offset:4096
    s_waitcnt lgkmcnt(8)
    v_mfma_f32_32x32x16_bf16 v[208:223], v[44:47], v[72:75], v[208:223]
    ds_read_b64_tr_b16 v[58:59], v13 offset:5120
    ds_read_b128 v[92:95], v11 offset:4096
    s_waitcnt lgkmcnt(8)
    v_mfma_f32_32x32x16_bf16 v[224:239], v[48:51], v[72:75], v[224:239]
    ds_read_b64_tr_b16 v[60:61], v13 offset:4352
    ds_read_b64_tr_b16 v[62:63], v13 offset:5376
    s_waitcnt lgkmcnt(8)
    v_mfma_f32_32x32x16_bf16 v[240:255], v[52:55], v[72:75], v[240:255]
    ds_read_b64_tr_b16 v[64:65], v13 offset:4608
    ds_read_b64_tr_b16 v[66:67], v13 offset:5632
    v_mfma_f32_32x32x16_bf16 v[144:159], v[52:55], v[76:79], v[144:159]
    ds_read_b64_tr_b16 v[68:69], v13 offset:4864
    ds_read_b64_tr_b16 v[70:71], v13 offset:5888
    s_waitcnt lgkmcnt(11)
    v_mfma_f32_32x32x16_bf16 v[160:175], v[52:55], v[80:83], v[160:175]
    ds_read_b128 v[96:99], v11 offset:8192
    ds_read_b128 v[100:103], v11 offset:12288
    s_waitcnt lgkmcnt(12)
    v_mfma_f32_32x32x16_bf16 v[176:191], v[52:55], v[84:87], v[176:191]
    s_waitcnt lgkmcnt(9)
    v_mfma_f32_32x32x16_bf16 v[192:207], v[56:59], v[88:91], v[192:207]
    ds_read_b128 v[72:75], v10 offset:512
    ds_read_b64_tr_b16 v[40:41], v13 offset:8192
    s_waitcnt lgkmcnt(8)
    v_mfma_f32_32x32x16_bf16 v[208:223], v[60:63], v[88:91], v[208:223]
    ds_read_b64_tr_b16 v[42:43], v13 offset:9216
    ds_read_b128 v[76:79], v10 offset:4608
    s_waitcnt lgkmcnt(8)
    v_mfma_f32_32x32x16_bf16 v[224:239], v[64:67], v[88:91], v[224:239]
    ds_read_b64_tr_b16 v[44:45], v13 offset:8448
    ds_read_b64_tr_b16 v[46:47], v13 offset:9472
    s_waitcnt lgkmcnt(8)
    v_mfma_f32_32x32x16_bf16 v[240:255], v[68:71], v[88:91], v[240:255]
    ds_read_b64_tr_b16 v[48:49], v13 offset:8704
    ds_read_b64_tr_b16 v[50:51], v13 offset:9728
    v_mfma_f32_32x32x16_bf16 v[144:159], v[68:71], v[92:95], v[144:159]
    ds_read_b64_tr_b16 v[52:53], v13 offset:8960
    ds_read_b64_tr_b16 v[54:55], v13 offset:9984
    s_waitcnt lgkmcnt(11)
    v_mfma_f32_32x32x16_bf16 v[160:175], v[68:71], v[96:99], v[160:175]
    ds_read_b128 v[80:83], v10 offset:8704
    ds_read_b128 v[84:87], v10 offset:12800
    s_waitcnt lgkmcnt(12)
    v_mfma_f32_32x32x16_bf16 v[176:191], v[68:71], v[100:103], v[176:191]
    s_mov_b32 s4, s86
    s_mov_b32 s86, s87
    s_mov_b32 s87, s88
    s_mov_b32 s88, s4
    s_waitcnt lgkmcnt(9)
    v_mfma_f32_32x32x16_bf16 v[192:207], v[40:43], v[72:75], v[192:207]
    ds_read_b128 v[88:91], v11 offset:512
    ds_read_b64_tr_b16 v[56:57], v13 offset:12288
    ds_read_b64_tr_b16 v[58:59], v13 offset:13312
    s_waitcnt lgkmcnt(9)
    v_mfma_f32_32x32x16_bf16 v[208:223], v[44:47], v[72:75], v[208:223]
    ds_read_b128 v[92:95], v11 offset:4608
    ds_read_b64_tr_b16 v[60:61], v13 offset:12544
    ds_read_b64_tr_b16 v[62:63], v13 offset:13568
    s_waitcnt lgkmcnt(10)
    v_mfma_f32_32x32x16_bf16 v[224:239], v[48:51], v[72:75], v[224:239]
    ds_read_b64_tr_b16 v[64:65], v13 offset:12800
    ds_read_b64_tr_b16 v[66:67], v13 offset:13824
    ds_read_b64_tr_b16 v[68:69], v13 offset:13056
    s_waitcnt lgkmcnt(11)
    v_mfma_f32_32x32x16_bf16 v[240:255], v[52:55], v[72:75], v[240:255]
    ds_read_b64_tr_b16 v[70:71], v13 offset:14080
    ds_read_b128 v[96:99], v11 offset:8704
    ds_read_b128 v[100:103], v11 offset:12800
    v_mfma_f32_32x32x16_bf16 v[144:159], v[52:55], v[76:79], v[144:159]
    ds_read_b32 v34, v32
    v_mov_b32 v35, s85
    s_add_u32 s85, s85, 1
    v_add_u32 v27, 1, v27
    s_mov_b32 s4, s89
    s_mov_b32 s89, s90
    s_mov_b32 s90, s91
    s_mov_b32 s91, s4
    s_add_u32 s10, s10, 1
    s_cmp_gt_u32 s10, 6
    s_waitcnt lgkmcnt(14)
    v_mfma_f32_32x32x16_bf16 v[160:175], v[52:55], v[80:83], v[160:175]
    s_waitcnt lgkmcnt(0)
    s_cbranch_scc1 L_QRELB
    s_barrier
    v_mfma_f32_32x32x16_bf16 v[176:191], v[52:55], v[84:87], v[176:191]
    s_branch L_QLOOPB
L_QRELB:
    ds_write_b32 v33, v35
    s_cmp_lt_u32 s10, 9
    v_mfma_f32_32x32x16_bf16 v[176:191], v[52:55], v[84:87], v[176:191]
    s_cbranch_scc1 L_QLOOPB
    v_mfma_f32_32x32x16_bf16 v[144:159], v[68:71], v[92:95], v[144:159]
    v_mfma_f32_32x32x16_bf16 v[160:175], v[68:71], v[96:99], v[160:175]
    v_mfma_f32_32x32x16_bf16 v[176:191], v[68:71], v[100:103], v[176:191]
    v_mfma_f32_32x32x16_bf16 v[192:207], v[56:59], v[88:91], v[192:207]
    v_mfma_f32_32x32x16_bf16 v[208:223], v[60:63], v[88:91], v[208:223]
    v_mfma_f32_32x32x16_bf16 v[224:239], v[64:67], v[88:91], v[224:239]
    v_mfma_f32_32x32x16_bf16 v[240:255], v[68:71], v[88:91], v[240:255]
L_QDONE:
    v_sub_u32 v27, 10, v28
    v_cmp_gt_i32 vcc, v27, v34
    s_cbranch_vccnz L_SPIN5
L_SRET6:
    v_mul_u32_u24 v7, 3, v28
    v_sub_u32 v27, 10, v7
    ds_read_b128 v[72:75], v16 offset:0
    ds_read_b128 v[76:79], v17 offset:0
    ds_read_b128 v[80:83], v16 offset:256
    ds_read_b128 v[84:87], v17 offset:256
    ds_read_b128 v[88:91], v16 offset:512
    ds_read_b128 v[92:95], v17 offset:512
    ds_read_b128 v[96:99], v16 offset:768
    ds_read_b128 v[100:103], v17 offset:768
    s_mov_b32 s4, 0x3e0293ee
    s_mov_b32 s5, 0x3e0293ee
    v_pk_mul_f32 v[144:145], v[144:145], s[4:5]
    v_pk_mul_f32 v[146:147], v[146:147], s[4:5]
    v_pk_mul_f32 v[148:149], v[148:149], s[4:5]
    v_pk_mul_f32 v[150:151], v[150:151], s[4:5]
    v_pk_mul_f32 v[152:153], v[152:153], s[4:5]
    v_pk_mul_f32 v[154:155], v[154:155], s[4:5]
    v_pk_mul_f32 v[156:157], v[156:157], s[4:5]
    v_pk_mul_f32 v[158:159], v[158:159], s[4:5]
    v_cvt_pk_bf16_f32 v144, v144, v145
    v_cvt_pk_bf16_f32 v145, v146, v147
    v_cvt_pk_bf16_f32 v146, v148, v149
    v_cvt_pk_bf16_f32 v147, v150, v151
    v_cvt_pk_bf16_f32 v148, v152, v153
    v_cvt_pk_bf16_f32 v149, v154, v155
    v_cvt_pk_bf16_f32 v150, v156, v157
    v_cvt_pk_bf16_f32 v151, v158, v159
    ds_write_b128 v29, v[144:147]
    ds_write_b128 v29, v[148:151] offset:1024
    v_pk_mul_f32 v[160:161], v[160:161], s[4:5]
    v_pk_mul_f32 v[162:163], v[162:163], s[4:5]
    v_pk_mul_f32 v[164:165], v[164:165], s[4:5]
    v_pk_mul_f32 v[166:167], v[166:167], s[4:5]
    v_pk_mul_f32 v[168:169], v[168:169], s[4:5]
    v_pk_mul_f32 v[170:171], v[170:171], s[4:5]
    v_pk_mul_f32 v[172:173], v[172:173], s[4:5]
    v_pk_mul_f32 v[174:175], v[174:175], s[4:5]
    v_cvt_pk_bf16_f32 v160, v160, v161
    v_cvt_pk_bf16_f32 v161, v162, v163
    v_cvt_pk_bf16_f32 v162, v164, v165
    v_cvt_pk_bf16_f32 v163, v166, v167
    v_cvt_pk_bf16_f32 v164, v168, v169
    v_cvt_pk_bf16_f32 v165, v170, v171
    v_cvt_pk_bf16_f32 v166, v172, v173
    v_cvt_pk_bf16_f32 v167, v174, v175
    ds_write_b128 v30, v[160:163]
    ds_write_b128 v30, v[164:167] offset:1024
    v_pk_mul_f32 v[176:177], v[176:177], s[4:5]
    v_pk_mul_f32 v[178:179], v[178:179], s[4:5]
    v_pk_mul_f32 v[180:181], v[180:181], s[4:5]
    v_pk_mul_f32 v[182:183], v[182:183], s[4:5]
    v_pk_mul_f32 v[184:185], v[184:185], s[4:5]
    v_pk_mul_f32 v[186:187], v[186:187], s[4:5]
    v_pk_mul_f32 v[188:189], v[188:189], s[4:5]
    v_pk_mul_f32 v[190:191], v[190:191], s[4:5]
    v_cvt_pk_bf16_f32 v176, v176, v177
    v_cvt_pk_bf16_f32 v177, v178, v179
    v_cvt_pk_bf16_f32 v178, v180, v181
    v_cvt_pk_bf16_f32 v179, v182, v183
    v_cvt_pk_bf16_f32 v180, v184, v185
    v_cvt_pk_bf16_f32 v181, v186, v187
    v_cvt_pk_bf16_f32 v182, v188, v189
    v_cvt_pk_bf16_f32 v183, v190, v191
    ds_write_b128 v31, v[176:179]
    ds_write_b128 v31, v[180:183] offset:1024
    ds_read_b128 v[40:43], v16 offset:8192
    ds_read_b128 v[44:47], v17 offset:8192
    ds_read_b128 v[48:51], v16 offset:8448
    ds_read_b128 v[52:55], v17 offset:8448
    ds_read_b128 v[56:59], v16 offset:8704
    ds_read_b128 v[60:63], v17 offset:8704
    ds_read_b128 v[64:67], v16 offset:8960
    ds_read_b128 v[68:71], v17 offset:8960
    v_mov_b32 v35, s85
    ds_write_b32 v33, v35
    s_add_u32 s85, s85, 1
    v_add_u32 v27, 1, v27
    ds_read_b32 v34, v32
    v_pk_mul_f32 v[192:193], v[192:193], s[4:5]
    v_pk_mul_f32 v[194:195], v[194:195], s[4:5]
    v_pk_mul_f32 v[196:197], v[196:197], s[4:5]
    v_pk_mul_f32 v[198:199], v[198:199], s[4:5]
    v_cvt_pk_bf16_f32 v112, v192, v193
    v_cvt_pk_bf16_f32 v113, v194, v195
    v_cvt_pk_bf16_f32 v114, v196, v197
    v_cvt_pk_bf16_f32 v115, v198, v199
    v_pk_mul_f32 v[200:201], v[200:201], s[4:5]
    v_pk_mul_f32 v[202:203], v[202:203], s[4:5]
    v_pk_mul_f32 v[204:205], v[204:205], s[4:5]
    v_pk_mul_f32 v[206:207], v[206:207], s[4:5]
    v_cvt_pk_bf16_f32 v116, v200, v201
    v_cvt_pk_bf16_f32 v117, v202, v203
    v_cvt_pk_bf16_f32 v118, v204, v205
    v_cvt_pk_bf16_f32 v119, v206, v207
    s_waitcnt lgkmcnt(15)
    v_mfma_f32_32x32x16_bf16 v[160:175], v[72:75], v[112:115], 0
    v_mov_b32 v192, 0
    v_mov_b32 v193, 0
    v_mov_b32 v194, 0
    v_mov_b32 v195, 0
    v_mov_b32 v196, 0
    v_mov_b32 v197, 0
    v_mov_b32 v198, 0
    v_mov_b32 v199, 0
    v_pk_mul_f32 v[208:209], v[208:209], s[4:5]
    v_pk_mul_f32 v[210:211], v[210:211], s[4:5]
    v_pk_mul_f32 v[212:213], v[212:213], s[4:5]
    v_pk_mul_f32 v[214:215], v[214:215], s[4:5]
    v_cvt_pk_bf16_f32 v120, v208, v209
    v_cvt_pk_bf16_f32 v121, v210, v211
    v_cvt_pk_bf16_f32 v122, v212, v213
    v_cvt_pk_bf16_f32 v123, v214, v215
    v_mfma_f32_32x32x16_bf16 v[160:175], v[76:79], v[116:119], v[160:175]
    v_mov_b32 v200, 0
    v_mov_b32 v201, 0
    v_mov_b32 v202, 0
    v_mov_b32 v203, 0
    v_mov_b32 v204, 0
    v_mov_b32 v205, 0
    v_mov_b32 v206, 0
    v_mov_b32 v207, 0
    v_pk_mul_f32 v[216:217], v[216:217], s[4:5]
    v_pk_mul_f32 v[218:219], v[218:219], s[4:5]
    v_pk_mul_f32 v[220:221], v[220:221], s[4:5]
    v_pk_mul_f32 v[222:223], v[222:223], s[4:5]
    v_cvt_pk_bf16_f32 v124, v216, v217
    v_cvt_pk_bf16_f32 v125, v218, v219
    v_cvt_pk_bf16_f32 v126, v220, v221
    v_cvt_pk_bf16_f32 v127, v222, v223
    v_mfma_f32_32x32x16_bf16 v[160:175], v[80:83], v[120:123], v[160:175]
    v_mov_b32 v208, 0
    v_mov_b32 v209, 0
    v_mov_b32 v210, 0
    v_mov_b32 v211, 0
    v_mov_b32 v212, 0
    v_mov_b32 v213, 0
    v_mov_b32 v214, 0
    v_mov_b32 v215, 0
    v_pk_mul_f32 v[224:225], v[224:225], s[4:5]
    v_pk_mul_f32 v[226:227], v[226:227], s[4:5]
    v_pk_mul_f32 v[228:229], v[228:229], s[4:5]
    v_pk_mul_f32 v[230:231], v[230:231], s[4:5]
    v_cvt_pk_bf16_f32 v128, v224, v225
    v_cvt_pk_bf16_f32 v129, v226, v227
    v_cvt_pk_bf16_f32 v130, v228, v229
    v_cvt_pk_bf16_f32 v131, v230, v231
    v_mfma_f32_32x32x16_bf16 v[160:175], v[84:87], v[124:127], v[160:175]
    v_mov_b32 v216, 0
    v_mov_b32 v217, 0
    v_mov_b32 v218, 0
    v_mov_b32 v219, 0
    v_mov_b32 v220, 0
    v_mov_b32 v221, 0
    v_mov_b32 v222, 0
    v_mov_b32 v223, 0
    v_pk_mul_f32 v[232:233], v[232:233], s[4:5]
    v_pk_mul_f32 v[234:235], v[234:235], s[4:5]
    v_pk_mul_f32 v[236:237], v[236:237], s[4:5]
    v_pk_mul_f32 v[238:239], v[238:239], s[4:5]
    v_cvt_pk_bf16_f32 v132, v232, v233
    v_cvt_pk_bf16_f32 v133, v234, v235
    v_cvt_pk_bf16_f32 v134, v236, v237
    v_cvt_pk_bf16_f32 v135, v238, v239
    v_mfma_f32_32x32x16_bf16 v[160:175], v[88:91], v[128:131], v[160:175]
    v_mov_b32 v224, 0
    v_mov_b32 v225, 0
    v_mov_b32 v226, 0
    v_mov_b32 v227, 0
    v_mov_b32 v228, 0
    v_mov_b32 v229, 0
    v_mov_b32 v230, 0
    v_mov_b32 v231, 0
    v_pk_mul_f32 v[240:241], v[240:241], s[4:5]
    v_pk_mul_f32 v[242:243], v[242:243], s[4:5]
    v_pk_mul_f32 v[244:245], v[244:245], s[4:5]
    v_pk_mul_f32 v[246:247], v[246:247], s[4:5]
    v_cvt_pk_bf16_f32 v136, v240, v241
    v_cvt_pk_bf16_f32 v137, v242, v243
    v_cvt_pk_bf16_f32 v138, v244, v245
    v_cvt_pk_bf16_f32 v139, v246, v247
    v_mfma_f32_32x32x16_bf16 v[160:175], v[92:95], v[132:135], v[160:175]
    v_mov_b32 v232, 0
    v_mov_b32 v233, 0
    v_mov_b32 v234, 0
    v_mov_b32 v235, 0
    v_mov_b32 v236, 0
    v_mov_b32 v237, 0
    v_mov_b32 v238, 0
    v_mov_b32 v239, 0
    v_pk_mul_f32 v[248:249], v[248:249], s[4:5]
    v_pk_mul_f32 v[250:251], v[250:251], s[4:5]
    v_pk_mul_f32 v[252:253], v[252:253], s[4:5]
    v_pk_mul_f32 v[254:255], v[254:255], s[4:5]
    v_cvt_pk_bf16_f32 v140, v248, v249
    v_cvt_pk_bf16_f32 v141, v250, v251
    v_cvt_pk_bf16_f32 v142, v252, v253
    v_cvt_pk_bf16_f32 v143, v254, v255
    v_mfma_f32_32x32x16_bf16 v[160:175], v[96:99], v[136:139], v[160:175]
    v_mov_b32 v240, 0
    v_mov_b32 v241, 0
    v_mov_b32 v242, 0
    v_mov_b32 v243, 0
    v_mov_b32 v244, 0
    v_mov_b32 v245, 0
    v_mov_b32 v246, 0
    v_mov_b32 v247, 0
    v_mfma_f32_32x32x16_bf16 v[160:175], v[100:103], v[140:143], v[160:175]
    v_mov_b32 v248, 0
    v_mov_b32 v249, 0
    v_mov_b32 v250, 0
    v_mov_b32 v251, 0
    v_mov_b32 v252, 0
    v_mov_b32 v253, 0
    v_mov_b32 v254, 0
    v_mov_b32 v255, 0
    s_branch L_ATT
L_QWAIT:
    s_cmp_lg_u32 s3, 4
    s_cbranch_scc1 L_HK1
    buffer_store_dword v0, v37, s[48:51], s15 offen
    s_waitcnt vmcnt(0)
L_HK1:
    s_barrier
    s_cmp_lg_u32 s3, 5
    s_cbranch_scc1 L_HK2
    s_cmp_lg_u32 s2, 0
    s_cbranch_scc1 L_HK2
    s_memrealtime s[4:5]
    s_waitcnt lgkmcnt(0)
    s_mul_i32 s5, s5, 0x9e3779b1
    s_xor_b32 s4, s4, s5
    s_lshl_b32 s4, s4, 4
    s_or_b32 s4, s4, 0x80000000
    v_mov_b32 v30, s4
    v_mov_b32 v29, 0
    buffer_store_dword v30, v29, s[60:63], 0 offen sc1
L_HK2:
    s_waitcnt vmcnt(0)
    s_barrier
    s_barrier
    s_barrier
    s_barrier
    s_barrier
    s_barrier
    s_waitcnt lgkmcnt(0)
    s_mov_b32 s85, 10
    v_cmp_gt_u32 vcc, 4, v0
    s_nop 1
    v_cndmask_b32 v7, v28, 0, vcc
    v_sub_u32 v27, 10, v7
    s_sub_u32 s4, s3, 4
    s_lshl_b32 s4, s4, 13
    s_add_u32 s4, s4, 57344
    v_add_u32 v29, s4, v36
    v_mov_b32 v192, 0
    v_mov_b32 v193, 0
    v_mov_b32 v194, 0
    v_mov_b32 v195, 0
    v_mov_b32 v196, 0
    v_mov_b32 v197, 0
    v_mov_b32 v198, 0
    v_mov_b32 v199, 0
    v_mov_b32 v200, 0
    v_mov_b32 v201, 0
    v_mov_b32 v202, 0
    v_mov_b32 v203, 0
    v_mov_b32 v204, 0
    v_mov_b32 v205, 0
    v_mov_b32 v206, 0
    v_mov_b32 v207, 0
    v_mov_b32 v208, 0
    v_mov_b32 v209, 0
    v_mov_b32 v210, 0
    v_mov_b32 v211, 0
    v_mov_b32 v212, 0
    v_mov_b32 v213, 0
    v_mov_b32 v214, 0
    v_mov_b32 v215, 0
    v_mov_b32 v216, 0
    v_mov_b32 v217, 0
    v_mov_b32 v218, 0
    v_mov_b32 v219, 0
    v_mov_b32 v220, 0
    v_mov_b32 v221, 0
    v_mov_b32 v222, 0
    v_mov_b32 v223, 0
    v_mov_b32 v224, 0
    v_mov_b32 v225, 0
    v_mov_b32 v226, 0
    v_mov_b32 v227, 0
    v_mov_b32 v228, 0
    v_mov_b32 v229, 0
    v_mov_b32 v230, 0
    v_mov_b32 v231, 0
    v_mov_b32 v232, 0
    v_mov_b32 v233, 0
    v_mov_b32 v234, 0
    v_mov_b32 v235, 0
    v_mov_b32 v236, 0
    v_mov_b32 v237, 0
    v_mov_b32 v238, 0
    v_mov_b32 v239, 0
    v_mov_b32 v240, 0
    v_mov_b32 v241, 0
    v_mov_b32 v242, 0
    v_mov_b32 v243, 0
    v_mov_b32 v244, 0
    v_mov_b32 v245, 0
    v_mov_b32 v246, 0
    v_mov_b32 v247, 0
    v_mov_b32 v248, 0
    v_mov_b32 v249, 0
    v_mov_b32 v250, 0
    v_mov_b32 v251, 0
    v_mov_b32 v252, 0
    v_mov_b32 v253, 0
    v_mov_b32 v254, 0
    v_mov_b32 v255, 0
    v_cmp_gt_i32 vcc, v27, v34
    s_cbranch_vccnz L_SPIN7
L_SRET8:
    ds_read_b128 v[112:115], v29 offset:0
    ds_read_b128 v[72:75], v16 offset:0
    ds_read_b128 v[116:119], v29 offset:1024
    ds_read_b128 v[76:79], v17 offset:0
    ds_read_b128 v[120:123], v29 offset:2048
    ds_read_b128 v[80:83], v16 offset:256
    ds_read_b128 v[124:127], v29 offset:3072
    ds_read_b128 v[84:87], v17 offset:256
    ds_read_b128 v[128:131], v29 offset:4096
    ds_read_b128 v[88:91], v16 offset:512
    ds_read_b128 v[132:135], v29 offset:5120
    ds_read_b128 v[92:95], v17 offset:512
    ds_read_b128 v[136:139], v29 offset:6144
    ds_read_b128 v[96:99], v16 offset:768
    ds_read_b128 v[140:143], v29 offset:7168
    ds_read_b128 v[100:103], v17 offset:768
    v_mul_u32_u24 v7, 3, v28
    v_sub_u32 v27, 10, v7
    s_waitcnt lgkmcnt(14)
    v_mfma_f32_32x32x16_bf16 v[160:175], v[72:75], v[112:115], 0
    ds_read_b128 v[40:43], v16 offset:8192
    s_waitcnt lgkmcnt(13)
    v_mfma_f32_32x32x16_bf16 v[160:175], v[76:79], v[116:119], v[160:175]
    ds_read_b128 v[44:47], v17 offset:8192
    ds_read_b128 v[48:51], v16 offset:8448
    s_waitcnt lgkmcnt(13)
    v_mfma_f32_32x32x16_bf16 v[160:175], v[80:83], v[120:123], v[160:175]
    ds_read_b128 v[52:55], v17 offset:8448
    s_waitcnt lgkmcnt(12)
    v_mfma_f32_32x32x16_bf16 v[160:175], v[84:87], v[124:127], v[160:175]
    ds_read_b128 v[56:59], v16 offset:8704
    ds_read_b128 v[60:63], v17 offset:8704
    s_waitcnt lgkmcnt(12)
    v_mfma_f32_32x32x16_bf16 v[160:175], v[88:91], v[128:131], v[160:175]
    ds_read_b128 v[64:67], v16 offset:8960
    ds_read_b128 v[68:71], v17 offset:8960
    s_waitcnt lgkmcnt(12)
    v_mfma_f32_32x32x16_bf16 v[160:175], v[92:95], v[132:135], v[160:175]
    v_mov_b32 v35, s85
    s_waitcnt lgkmcnt(10)
    v_mfma_f32_32x32x16_bf16 v[160:175], v[96:99], v[136:139], v[160:175]
    ds_write_b32 v33, v35
    s_add_u32 s85, s85, 1
    s_waitcnt lgkmcnt(9)
    v_mfma_f32_32x32x16_bf16 v[160:175], v[100:103], v[140:143], v[160:175]
    v_add_u32 v27, 1, v27
    ds_read_b32 v34, v32
L_ATT:
    s_nop 7
    v_mov_b32 v22, 0
    v_mov_b32 v23, 0
    v_max3_f32 v24, v160, v161, v162
    v_max3_f32 v25, v163, v164, v165
    v_max3_f32 v24, v24, v166, v167
    v_max3_f32 v25, v25, v168, v169
    v_max3_f32 v24, v24, v170, v171
    v_max3_f32 v25, v25, v172, v173
    v_max3_f32 v24, v24, v174, v175
    v_max_f32 v24, v24, v25
    v_mov_b32 v25, v24
    s_nop 1
    v_permlane32_swap_b32 v24, v25
    v_max_f32 v24, v24, v25
    v_sub_f32 v160, v160, v24
    v_sub_f32 v144, 0, v24
    v_sub_f32 v161, v161, v24
    v_sub_f32 v145, 0, v24
    v_sub_f32 v162, v162, v24
    v_sub_f32 v146, 0, v24
    v_sub_f32 v163, v163, v24
    v_sub_f32 v147, 0, v24
    v_sub_f32 v164, v164, v24
    v_sub_f32 v148, 0, v24
    v_sub_f32 v165, v165, v24
    v_sub_f32 v149, 0, v24
    v_sub_f32 v166, v166, v24
    v_sub_f32 v150, 0, v24
    v_sub_f32 v167, v167, v24
    v_sub_f32 v151, 0, v24
    v_sub_f32 v168, v168, v24
    v_sub_f32 v152, 0, v24
    v_sub_f32 v169, v169, v24
    v_sub_f32 v153, 0, v24
    v_sub_f32 v170, v170, v24
    v_sub_f32 v154, 0, v24
    v_sub_f32 v171, v171, v24
    v_sub_f32 v155, 0, v24
    v_sub_f32 v172, v172, v24
    v_sub_f32 v156, 0, v24
    v_sub_f32 v173, v173, v24
    v_sub_f32 v157, 0, v24
    v_sub_f32 v174, v174, v24
    v_sub_f32 v158, 0, v24
    v_sub_f32 v175, v175, v24
    v_sub_f32 v159, 0, v24
    s_mov_b32 s10, 0
    s_mov_b32 s86, 16384
    s_mov_b32 s87, 147456
    s_mov_b32 s88, 0x41000000
    s_waitcnt lgkmcnt(0)
    v_add_u32 v21, s87, v18
    v_add_u32 v19, s86, v16
    v_add_u32 v20, s86, v17
    v_cmp_gt_i32 vcc, v27, v34
    s_cbranch_vccnz L_SPIN9
L_SRET10:
L_ALOOP:
    v_mfma_f32_32x32x16_bf16 v[176:191], v[40:43], v[112:115], v[144:159]
    ds_read_b64_tr_b16 v[72:73], v21 offset:8192
    ds_read_b64_tr_b16 v[74:75], v21 offset:10240
    v_exp_f32 v160, v160
    v_exp_f32 v161, v161
    ds_read_b64_tr_b16 v[76:77], v21 offset:8448
    v_mfma_f32_32x32x16_bf16 v[176:191], v[44:47], v[116:119], v[176:191]
    ds_read_b64_tr_b16 v[78:79], v21 offset:10496
    v_exp_f32 v162, v162
    v_exp_f32 v163, v163
    v_cvt_pk_bf16_f32 v104, v160, v161
    ds_read_b64_tr_b16 v[80:81], v21 offset:8704
    v_mfma_f32_32x32x16_bf16 v[176:191], v[48:51], v[120:123], v[176:191]
    ds_read_b64_tr_b16 v[82:83], v21 offset:10752
    v_exp_f32 v164, v164
    v_exp_f32 v165, v165
    v_cvt_pk_bf16_f32 v105, v162, v163
    ds_read_b64_tr_b16 v[84:85], v21 offset:8960
    v_mfma_f32_32x32x16_bf16 v[176:191], v[52:55], v[124:127], v[176:191]
    ds_read_b64_tr_b16 v[86:87], v21 offset:11008
    v_exp_f32 v166, v166
    v_exp_f32 v167, v167
    v_cvt_pk_bf16_f32 v106, v164, v165
    ds_read_b64_tr_b16 v[88:89], v21 offset:12288
    v_mfma_f32_32x32x16_bf16 v[176:191], v[56:59], v[128:131], v[176:191]
    ds_read_b64_tr_b16 v[90:91], v21 offset:14336
    v_exp_f32 v168, v168
    v_exp_f32 v169, v169
    v_cvt_pk_bf16_f32 v107, v166, v167
    ds_read_b64_tr_b16 v[92:93], v21 offset:12544
    v_mfma_f32_32x32x16_bf16 v[176:191], v[60:63], v[132:135], v[176:191]
    ds_read_b64_tr_b16 v[94:95], v21 offset:14592
    v_exp_f32 v170, v170
    v_exp_f32 v171, v171
    v_cvt_pk_bf16_f32 v108, v168, v169
    ds_read_b64_tr_b16 v[96:97], v21 offset:12800
    v_mfma_f32_32x32x16_bf16 v[176:191], v[64:67], v[136:139], v[176:191]
    ds_read_b64_tr_b16 v[98:99], v21 offset:14848
    v_exp_f32 v172, v172
    v_exp_f32 v173, v173
    v_cvt_pk_bf16_f32 v109, v170, v171
    ds_read_b64_tr_b16 v[100:101], v21 offset:13056
    v_mfma_f32_32x32x16_bf16 v[176:191], v[68:71], v[140:143], v[176:191]
    ds_read_b64_tr_b16 v[102:103], v21 offset:15104
    v_exp_f32 v174, v174
    v_exp_f32 v175, v175
    v_cvt_pk_bf16_f32 v110, v172, v173
    v_cvt_pk_bf16_f32 v111, v174, v175
    s_waitcnt lgkmcnt(14)
    v_mfma_f32_32x32x16_bf16 v[192:207], v[72:75], v[104:107], v[192:207]
    ds_read_b128 v[40:43], v19 offset:0
    ds_read_b128 v[44:47], v20 offset:0
    ds_read_b128 v[48:51], v19 offset:256
    ds_read_b128 v[52:55], v20 offset:256
    v_add_f32 v22, v22, v160
    v_add_f32 v23, v23, v161
    s_waitcnt lgkmcnt(15)
    v_mfma_f32_32x32x16_bf16 v[208:223], v[76:79], v[104:107], v[208:223]
    ds_read_b128 v[56:59], v19 offset:512
    ds_read_b128 v[60:63], v20 offset:512
    ds_read_b128 v[64:67], v19 offset:768
    ds_read_b128 v[68:71], v20 offset:768
    v_add_f32 v22, v22, v162
    v_add_f32 v23, v23, v163
    s_waitcnt lgkmcnt(15)
    v_mfma_f32_32x32x16_bf16 v[224:239], v[80:83], v[104:107], v[224:239]
    v_mov_b32 v35, s85
    ds_write_b32 v33, v35
    s_add_u32 s85, s85, 1
    v_add_u32 v27, 1, v27
    v_add_f32 v22, v22, v164
    v_add_f32 v23, v23, v165
    v_mfma_f32_32x32x16_bf16 v[240:255], v[84:87], v[104:107], v[240:255]
    ds_read_b32 v34, v32
    v_add_f32 v22, v22, v166
    v_add_f32 v23, v23, v167
    s_waitcnt lgkmcnt(15)
    v_mfma_f32_32x32x16_bf16 v[192:207], v[88:91], v[108:111], v[192:207]
    v_max3_f32 v24, v176, v177, v178
    v_max3_f32 v25, v179, v180, v181
    v_max3_f32 v24, v24, v182, v183
    v_max3_f32 v25, v25, v184, v185
    v_add_f32 v22, v22, v168
    v_add_f32 v23, v23, v169
    s_waitcnt lgkmcnt(14)
    v_mfma_f32_32x32x16_bf16 v[208:223], v[92:95], v[108:111], v[208:223]
    v_max3_f32 v24, v24, v186, v187
    v_max3_f32 v25, v25, v188, v189
    v_max3_f32 v24, v24, v190, v191
    v_max_f32 v24, v24, v25
    v_add_f32 v22, v22, v170
    v_add_f32 v23, v23, v171
    s_waitcnt lgkmcnt(12)
    v_mfma_f32_32x32x16_bf16 v[224:239], v[96:99], v[108:111], v[224:239]
    v_add_f32 v22, v22, v172
    v_add_f32 v23, v23, v173
    v_add_f32 v22, v22, v174
    v_add_f32 v23, v23, v175
    v_cmp_lt_f32 vcc, s88, v24
    s_waitcnt lgkmcnt(0)
    v_cmp_gt_i32 s[90:91], v27, v34
    v_mfma_f32_32x32x16_bf16 v[240:255], v[100:103], v[108:111], v[240:255]
    s_add_u32 s86, s86, 16384
    s_cmp_eq_u32 s86, 81920
    s_cselect_b32 s86, 0, s86
    s_sub_u32 s87, s87, 16384
    s_cmp_eq_u32 s87, 81920
    s_cselect_b32 s87, 147456, s87
    s_add_u32 s10, s10, 1
    s_or_b64 vcc, vcc, s[90:91]
    s_cbranch_vccnz L_RARE11
L_RRET12:
    v_mfma_f32_32x32x16_bf16 v[160:175], v[40:43], v[112:115], v[144:159]
    ds_read_b64_tr_b16 v[72:73], v21 offset:0
    ds_read_b64_tr_b16 v[74:75], v21 offset:2048
    v_exp_f32 v176, v176
    v_exp_f32 v177, v177
    ds_read_b64_tr_b16 v[76:77], v21 offset:256
    v_mfma_f32_32x32x16_bf16 v[160:175], v[44:47], v[116:119], v[160:175]
    ds_read_b64_tr_b16 v[78:79], v21 offset:2304
    v_exp_f32 v178, v178
    v_exp_f32 v179, v179
    v_cvt_pk_bf16_f32 v104, v176, v177
    ds_read_b64_tr_b16 v[80:81], v21 offset:512
    v_mfma_f32_32x32x16_bf16 v[160:175], v[48:51], v[120:123], v[160:175]
    ds_read_b64_tr_b16 v[82:83], v21 offset:2560
    v_exp_f32 v180, v180
    v_exp_f32 v181, v181
    v_cvt_pk_bf16_f32 v105, v178, v179
    ds_read_b64_tr_b16 v[84:85], v21 offset:768
    v_mfma_f32_32x32x16_bf16 v[160:175], v[52:55], v[124:127], v[160:175]
    ds_read_b64_tr_b16 v[86:87], v21 offset:2816
    v_exp_f32 v182, v182
    v_exp_f32 v183, v183
    v_cvt_pk_bf16_f32 v106, v180, v181
    ds_read_b64_tr_b16 v[88:89], v21 offset:4096
    v_mfma_f32_32x32x16_bf16 v[160:175], v[56:59], v[128:131], v[160:175]
    ds_read_b64_tr_b16 v[90:91], v21 offset:6144
    v_exp_f32 v184, v184
    v_exp_f32 v185, v185
    v_cvt_pk_bf16_f32 v107, v182, v183
    ds_read_b64_tr_b16 v[92:93], v21 offset:4352
    v_mfma_f32_32x32x16_bf16 v[160:175], v[60:63], v[132:135], v[160:175]
    ds_read_b64_tr_b16 v[94:95], v21 offset:6400
    v_exp_f32 v186, v186
    v_exp_f32 v187, v187
    v_cvt_pk_bf16_f32 v108, v184, v185
    ds_read_b64_tr_b16 v[96:97], v21 offset:4608
    v_mfma_f32_32x32x16_bf16 v[160:175], v[64:67], v[136:139], v[160:175]
    ds_read_b64_tr_b16 v[98:99], v21 offset:6656
    v_exp_f32 v188, v188
    v_exp_f32 v189, v189
    v_cvt_pk_bf16_f32 v109, v186, v187
    ds_read_b64_tr_b16 v[100:101], v21 offset:4864
    v_mfma_f32_32x32x16_bf16 v[160:175], v[68:71], v[140:143], v[160:175]
    ds_read_b64_tr_b16 v[102:103], v21 offset:6912
    v_exp_f32 v190, v190
    v_exp_f32 v191, v191
    v_cvt_pk_bf16_f32 v110, v188, v189
    v_cvt_pk_bf16_f32 v111, v190, v191
    s_waitcnt lgkmcnt(14)
    v_mfma_f32_32x32x16_bf16 v[192:207], v[72:75], v[104:107], v[192:207]
    ds_read_b128 v[40:43], v19 offset:8192
    ds_read_b128 v[44:47], v20 offset:8192
    ds_read_b128 v[48:51], v19 offset:8448
    ds_read_b128 v[52:55], v20 offset:8448
    v_add_f32 v22, v22, v176
    v_add_f32 v23, v23, v177
    s_waitcnt lgkmcnt(15)
    v_mfma_f32_32x32x16_bf16 v[208:223], v[76:79], v[104:107], v[208:223]
    ds_read_b128 v[56:59], v19 offset:8704
    ds_read_b128 v[60:63], v20 offset:8704
    ds_read_b128 v[64:67], v19 offset:8960
    ds_read_b128 v[68:71], v20 offset:8960
    v_add_f32 v22, v22, v178
    v_add_f32 v23, v23, v179
    s_waitcnt lgkmcnt(15)
    v_mfma_f32_32x32x16_bf16 v[224:239], v[80:83], v[104:107], v[224:239]
    v_mov_b32 v35, s85
    ds_write_b32 v33, v35
    s_add_u32 s85, s85, 1
    v_add_u32 v27, 1, v27
    v_add_f32 v22, v22, v180
    v_add_f32 v23, v23, v181
    v_mfma_f32_32x32x16_bf16 v[240:255], v[84:87], v[104:107], v[240:255]
    ds_read_b32 v34, v32
    v_add_f32 v22, v22, v182
    v_add_f32 v23, v23, v183
    s_waitcnt lgkmcnt(15)
    v_mfma_f32_32x32x16_bf16 v[192:207], v[88:91], v[108:111], v[192:207]
    v_max3_f32 v24, v160, v161, v162
    v_max3_f32 v25, v163, v164, v165
    v_max3_f32 v24, v24, v166, v167
    v_max3_f32 v25, v25, v168, v169
    v_add_f32 v22, v22, v184
    v_add_f32 v23, v23, v185
    s_waitcnt lgkmcnt(14)
    v_mfma_f32_32x32x16_bf16 v[208:223], v[92:95], v[108:111], v[208:223]
    v_max3_f32 v24, v24, v170, v171
    v_max3_f32 v25, v25, v172, v173
    v_max3_f32 v24, v24, v174, v175
    v_max_f32 v24, v24, v25
    v_add_f32 v22, v22, v186
    v_add_f32 v23, v23, v187
    s_waitcnt lgkmcnt(12)
    v_mfma_f32_32x32x16_bf16 v[224:239], v[96:99], v[108:111], v[224:239]
    v_add_f32 v22, v22, v188
    v_add_f32 v23, v23, v189
    v_add_f32 v22, v22, v190
    v_add_f32 v23, v23, v191
    v_cmp_lt_f32 vcc, s88, v24
    s_waitcnt lgkmcnt(0)
    v_cmp_gt_i32 s[90:91], v27, v34
    v_mfma_f32_32x32x16_bf16 v[240:255], v[100:103], v[108:111], v[240:255]
    v_add_u32 v21, s87, v18
    v_add_u32 v19, s86, v16
    v_add_u32 v20, s86, v17
    s_or_b64 vcc, vcc, s[90:91]
    s_cbranch_vccnz L_RARE13
L_RRET14:
    s_cmp_lt_u32 s10, 7
    s_waitcnt lgkmcnt(0)
    s_cbranch_scc1 L_ALOOP
    v_mfma_f32_32x32x16_bf16 v[176:191], v[40:43], v[112:115], v[144:159]
    ds_read_b64_tr_b16 v[72:73], v21 offset:8192
    ds_read_b64_tr_b16 v[74:75], v21 offset:10240
    v_exp_f32 v160, v160
    v_exp_f32 v161, v161
    ds_read_b64_tr_b16 v[76:77], v21 offset:8448
    v_mfma_f32_32x32x16_bf16 v[176:191], v[44:47], v[116:119], v[176:191]
    ds_read_b64_tr_b16 v[78:79], v21 offset:10496
    v_exp_f32 v162, v162
    v_exp_f32 v163, v163
    v_cvt_pk_bf16_f32 v104, v160, v161
    ds_read_b64_tr_b16 v[80:81], v21 offset:8704
    v_mfma_f32_32x32x16_bf16 v[176:191], v[48:51], v[120:123], v[176:191]
    ds_read_b64_tr_b16 v[82:83], v21 offset:10752
    v_exp_f32 v164, v164
    v_exp_f32 v165, v165
    v_cvt_pk_bf16_f32 v105, v162, v163
    ds_read_b64_tr_b16 v[84:85], v21 offset:8960
    v_mfma_f32_32x32x16_bf16 v[176:191], v[52:55], v[124:127], v[176:191]
    ds_read_b64_tr_b16 v[86:87], v21 offset:11008
    v_exp_f32 v166, v166
    v_exp_f32 v167, v167
    v_cvt_pk_bf16_f32 v106, v164, v165
    ds_read_b64_tr_b16 v[88:89], v21 offset:12288
    v_mfma_f32_32x32x16_bf16 v[176:191], v[56:59], v[128:131], v[176:191]
    ds_read_b64_tr_b16 v[90:91], v21 offset:14336
    v_exp_f32 v168, v168
    v_exp_f32 v169, v169
    v_cvt_pk_bf16_f32 v107, v166, v167
    ds_read_b64_tr_b16 v[92:93], v21 offset:12544
    v_mfma_f32_32x32x16_bf16 v[176:191], v[60:63], v[132:135], v[176:191]
    ds_read_b64_tr_b16 v[94:95], v21 offset:14592
    v_exp_f32 v170, v170
    v_exp_f32 v171, v171
    v_cvt_pk_bf16_f32 v108, v168, v169
    ds_read_b64_tr_b16 v[96:97], v21 offset:12800
    v_mfma_f32_32x32x16_bf16 v[176:191], v[64:67], v[136:139], v[176:191]
    ds_read_b64_tr_b16 v[98:99], v21 offset:14848
    v_exp_f32 v172, v172
    v_exp_f32 v173, v173
    v_cvt_pk_bf16_f32 v109, v170, v171
    ds_read_b64_tr_b16 v[100:101], v21 offset:13056
    v_mfma_f32_32x32x16_bf16 v[176:191], v[68:71], v[140:143], v[176:191]
    ds_read_b64_tr_b16 v[102:103], v21 offset:15104
    v_exp_f32 v174, v174
    v_exp_f32 v175, v175
    v_cvt_pk_bf16_f32 v110, v172, v173
    v_cvt_pk_bf16_f32 v111, v174, v175
    s_waitcnt lgkmcnt(14)
    v_mfma_f32_32x32x16_bf16 v[192:207], v[72:75], v[104:107], v[192:207]
    v_mov_b32 v35, s85
    ds_write_b32 v33, v35
    s_add_u32 s85, s85, 1
    v_add_u32 v27, 1, v27
    v_add_f32 v22, v22, v160
    v_add_f32 v23, v23, v161
    s_waitcnt lgkmcnt(13)
    v_mfma_f32_32x32x16_bf16 v[208:223], v[76:79], v[104:107], v[208:223]
    ds_read_b32 v34, v32
    v_add_f32 v22, v22, v162
    v_add_f32 v23, v23, v163
    s_waitcnt lgkmcnt(12)
    v_mfma_f32_32x32x16_bf16 v[224:239], v[80:83], v[104:107], v[224:239]
    v_add_f32 v22, v22, v164
    v_add_f32 v23, v23, v165
    s_waitcnt lgkmcnt(10)
    v_mfma_f32_32x32x16_bf16 v[240:255], v[84:87], v[104:107], v[240:255]
    v_add_f32 v22, v22, v166
    v_add_f32 v23, v23, v167
    s_waitcnt lgkmcnt(8)
    v_mfma_f32_32x32x16_bf16 v[192:207], v[88:91], v[108:111], v[192:207]
    v_max3_f32 v24, v176, v177, v178
    v_max3_f32 v25, v179, v180, v181
    v_max3_f32 v24, v24, v182, v183
    v_max3_f32 v25, v25, v184, v185
    v_add_f32 v22, v22, v168
    v_add_f32 v23, v23, v169
    s_waitcnt lgkmcnt(6)
    v_mfma_f32_32x32x16_bf16 v[208:223], v[92:95], v[108:111], v[208:223]
    v_max3_f32 v24, v24, v186, v187
    v_max3_f32 v25, v25, v188, v189
    v_max3_f32 v24, v24, v190, v191
    v_max_f32 v24, v24, v25
    v_add_f32 v22, v22, v170
    v_add_f32 v23, v23, v171
    s_waitcnt lgkmcnt(4)
    v_mfma_f32_32x32x16_bf16 v[224:239], v[96:99], v[108:111], v[224:239]
    v_add_f32 v22, v22, v172
    v_add_f32 v23, v23, v173
    v_add_f32 v22, v22, v174
    v_add_f32 v23, v23, v175
    v_cmp_lt_f32 vcc, s88, v24
    s_waitcnt lgkmcnt(0)
    v_cmp_gt_i32 s[90:91], v27, v34
    v_mfma_f32_32x32x16_bf16 v[240:255], v[100:103], v[108:111], v[240:255]
    s_or_b64 vcc, vcc, s[90:91]
    s_cbranch_vccnz L_RARE15
L_RRET16:
    ds_read_b64_tr_b16 v[72:73], v21 offset:0
    ds_read_b64_tr_b16 v[74:75], v21 offset:2048
    v_exp_f32 v176, v176
    v_exp_f32 v177, v177
    ds_read_b64_tr_b16 v[76:77], v21 offset:256
    ds_read_b64_tr_b16 v[78:79], v21 offset:2304
    v_exp_f32 v178, v178
    v_exp_f32 v179, v179
    v_cvt_pk_bf16_f32 v104, v176, v177
    ds_read_b64_tr_b16 v[80:81], v21 offset:512
    ds_read_b64_tr_b16 v[82:83], v21 offset:2560
    v_exp_f32 v180, v180
    v_exp_f32 v181, v181
    v_cvt_pk_bf16_f32 v105, v178, v179
    ds_read_b64_tr_b16 v[84:85], v21 offset:768
    ds_read_b64_tr_b16 v[86:87], v21 offset:2816
    v_exp_f32 v182, v182
    v_exp_f32 v183, v183
    v_cvt_pk_bf16_f32 v106, v180, v181
    ds_read_b64_tr_b16 v[88:89], v21 offset:4096
    ds_read_b64_tr_b16 v[90:91], v21 offset:6144
    v_exp_f32 v184, v184
    v_exp_f32 v185, v185
    v_cvt_pk_bf16_f32 v107, v182, v183
    ds_read_b64_tr_b16 v[92:93], v21 offset:4352
    ds_read_b64_tr_b16 v[94:95], v21 offset:6400
    v_exp_f32 v186, v186
    v_exp_f32 v187, v187
    v_cvt_pk_bf16_f32 v108, v184, v185
    ds_read_b64_tr_b16 v[96:97], v21 offset:4608
    ds_read_b64_tr_b16 v[98:99], v21 offset:6656
    v_exp_f32 v188, v188
    v_exp_f32 v189, v189
    v_cvt_pk_bf16_f32 v109, v186, v187
    ds_read_b64_tr_b16 v[100:101], v21 offset:4864
    ds_read_b64_tr_b16 v[102:103], v21 offset:6912
    v_exp_f32 v190, v190
    v_exp_f32 v191, v191
    v_cvt_pk_bf16_f32 v110, v188, v189
    v_cvt_pk_bf16_f32 v111, v190, v191
    s_waitcnt lgkmcnt(14)
    v_mfma_f32_32x32x16_bf16 v[192:207], v[72:75], v[104:107], v[192:207]
    v_mov_b32 v35, s85
    ds_write_b32 v33, v35
    s_add_u32 s85, s85, 1
    v_add_u32 v27, 1, v27
    v_add_f32 v22, v22, v176
    v_add_f32 v23, v23, v177
    s_waitcnt lgkmcnt(13)
    v_mfma_f32_32x32x16_bf16 v[208:223], v[76:79], v[104:107], v[208:223]
    v_add_f32 v22, v22, v178
    v_add_f32 v23, v23, v179
    s_waitcnt lgkmcnt(11)
    v_mfma_f32_32x32x16_bf16 v[224:239], v[80:83], v[104:107], v[224:239]
    v_add_f32 v22, v22, v180
    v_add_f32 v23, v23, v181
    s_waitcnt lgkmcnt(9)
    v_mfma_f32_32x32x16_bf16 v[240:255], v[84:87], v[104:107], v[240:255]
    v_add_f32 v22, v22, v182
    v_add_f32 v23, v23, v183
    s_waitcnt lgkmcnt(7)
    v_mfma_f32_32x32x16_bf16 v[192:207], v[88:91], v[108:111], v[192:207]
    v_add_f32 v22, v22, v184
    v_add_f32 v23, v23, v185
    s_waitcnt lgkmcnt(5)
    v_mfma_f32_32x32x16_bf16 v[208:223], v[92:95], v[108:111], v[208:223]
    v_add_f32 v22, v22, v186
    v_add_f32 v23, v23, v187
    s_waitcnt lgkmcnt(3)
    v_mfma_f32_32x32x16_bf16 v[224:239], v[96:99], v[108:111], v[224:239]
    v_add_f32 v22, v22, v188
    v_add_f32 v23, v23, v189
    v_add_f32 v22, v22, v190
    v_add_f32 v23, v23, v191
    s_waitcnt lgkmcnt(1)
    v_mfma_f32_32x32x16_bf16 v[240:255], v[100:103], v[108:111], v[240:255]
    v_add_u32 v32, 90112, v37
    ds_read_b32 v34, v32 offset:2048
    v_add_f32 v22, v22, v23
    v_mov_b32 v25, v22
    s_nop 1
    v_permlane32_swap_b32 v22, v25
    v_add_f32 v22, v22, v25
    v_rcp_f32 v22, v22
    s_nop 0
    v_mov_b32 v23, v22
    s_mul_i32 s6, s92, 28
    s_and_b32 s7, s8, 3
    s_mul_i32 s7, s7, 7
    s_add_u32 s6, s6, s7
    s_add_u32 s6, s6, s3
    s_lshl_b32 s4, s6, 16
    s_and_b32 s7, s9, 7
    s_lshl_b32 s7, s7, 2
    s_lshl_b32 s5, s7, 11
    s_add_u32 s4, s4, s5
    s_add_u32 s5, s4, 4096
    s_lshl_b32 s6, s6, 7
    s_add_u32 s6, s6, s7
    s_add_u32 s6, s6, 34603008
L_MODEW:
    s_waitcnt lgkmcnt(0)
    v_cmp_ne_u32 vcc, 0, v34
    s_cbranch_vccnz L_MODEG
    ds_read_b32 v34, v32 offset:2048
    s_waitcnt lgkmcnt(0)
    s_sleep 1
    s_add_u32 s84, s84, 1
    s_cmp_lt_u32 s84, 2097152
    s_cbranch_scc1 L_MODEW
    s_endpgm
L_MODEG:
    v_and_b32 v7, 2, v34
    v_and_b32 v38, -16, v34
    v_cmp_eq_u32 vcc, 2, v7
    v_mov_b32 v7, 0
    s_cbranch_vccz L_OSLOW
    v_pk_mul_f32 v[192:193], v[192:193], v[22:23]
    v_pk_mul_f32 v[194:195], v[194:195], v[22:23]
    v_pk_mul_f32 v[196:197], v[196:197], v[22:23]
    v_pk_mul_f32 v[198:199], v[198:199], v[22:23]
    v_pk_mul_f32 v[200:201], v[200:201], v[22:23]
    v_pk_mul_f32 v[202:203], v[202:203], v[22:23]
    v_pk_mul_f32 v[204:205], v[204:205], v[22:23]
    v_pk_mul_f32 v[206:207], v[206:207], v[22:23]
    v_cvt_pk_bf16_f32 v112, v192, v193
    v_cvt_pk_bf16_f32 v113, v194, v195
    v_cvt_pk_bf16_f32 v114, v196, v197
    v_cvt_pk_bf16_f32 v115, v198, v199
    v_cvt_pk_bf16_f32 v116, v200, v201
    v_cvt_pk_bf16_f32 v117, v202, v203
    v_cvt_pk_bf16_f32 v118, v204, v205
    v_cvt_pk_bf16_f32 v119, v206, v207
    buffer_store_dwordx4 v[112:115], v36, s[48:51], s4 offen offset:0
    buffer_store_dwordx4 v[116:119], v36, s[48:51], s4 offen offset:1024
    v_pk_mul_f32 v[208:209], v[208:209], v[22:23]
    v_pk_mul_f32 v[210:211], v[210:211], v[22:23]
    v_pk_mul_f32 v[212:213], v[212:213], v[22:23]
    v_pk_mul_f32 v[214:215], v[214:215], v[22:23]
    v_pk_mul_f32 v[216:217], v[216:217], v[22:23]
    v_pk_mul_f32 v[218:219], v[218:219], v[22:23]
    v_pk_mul_f32 v[220:221], v[220:221], v[22:23]
    v_pk_mul_f32 v[222:223], v[222:223], v[22:23]
    v_cvt_pk_bf16_f32 v120, v208, v209
    v_cvt_pk_bf16_f32 v121, v210, v211
    v_cvt_pk_bf16_f32 v122, v212, v213
    v_cvt_pk_bf16_f32 v123, v214, v215
    v_cvt_pk_bf16_f32 v124, v216, v217
    v_cvt_pk_bf16_f32 v125, v218, v219
    v_cvt_pk_bf16_f32 v126, v220, v221
    v_cvt_pk_bf16_f32 v127, v222, v223
    buffer_store_dwordx4 v[120:123], v36, s[48:51], s4 offen offset:2048
    buffer_store_dwordx4 v[124:127], v36, s[48:51], s4 offen offset:3072
    v_pk_mul_f32 v[224:225], v[224:225], v[22:23]
    v_pk_mul_f32 v[226:227], v[226:227], v[22:23]
    v_pk_mul_f32 v[228:229], v[228:229], v[22:23]
    v_pk_mul_f32 v[230:231], v[230:231], v[22:23]
    v_pk_mul_f32 v[232:233], v[232:233], v[22:23]
    v_pk_mul_f32 v[234:235], v[234:235], v[22:23]
    v_pk_mul_f32 v[236:237], v[236:237], v[22:23]
    v_pk_mul_f32 v[238:239], v[238:239], v[22:23]
    v_cvt_pk_bf16_f32 v128, v224, v225
    v_cvt_pk_bf16_f32 v129, v226, v227
    v_cvt_pk_bf16_f32 v130, v228, v229
    v_cvt_pk_bf16_f32 v131, v230, v231
    v_cvt_pk_bf16_f32 v132, v232, v233
    v_cvt_pk_bf16_f32 v133, v234, v235
    v_cvt_pk_bf16_f32 v134, v236, v237
    v_cvt_pk_bf16_f32 v135, v238, v239
    buffer_store_dwordx4 v[128:131], v36, s[48:51], s5 offen offset:0
    buffer_store_dwordx4 v[132:135], v36, s[48:51], s5 offen offset:1024
    v_pk_mul_f32 v[240:241], v[240:241], v[22:23]
    v_pk_mul_f32 v[242:243], v[242:243], v[22:23]
    v_pk_mul_f32 v[244:245], v[244:245], v[22:23]
    v_pk_mul_f32 v[246:247], v[246:247], v[22:23]
    v_pk_mul_f32 v[248:249], v[248:249], v[22:23]
    v_pk_mul_f32 v[250:251], v[250:251], v[22:23]
    v_pk_mul_f32 v[252:253], v[252:253], v[22:23]
    v_pk_mul_f32 v[254:255], v[254:255], v[22:23]
    v_cvt_pk_bf16_f32 v136, v240, v241
    v_cvt_pk_bf16_f32 v137, v242, v243
    v_cvt_pk_bf16_f32 v138, v244, v245
    v_cvt_pk_bf16_f32 v139, v246, v247
    v_cvt_pk_bf16_f32 v140, v248, v249
    v_cvt_pk_bf16_f32 v141, v250, v251
    v_cvt_pk_bf16_f32 v142, v252, v253
    v_cvt_pk_bf16_f32 v143, v254, v255
    buffer_store_dwordx4 v[136:139], v36, s[48:51], s5 offen offset:2048
    buffer_store_dwordx4 v[140:143], v36, s[48:51], s5 offen offset:3072
    s_waitcnt vmcnt(0)
    buffer_store_dword v38, v7, s[48:51], s6 offen
    s_branch L_P2
L_OSLOW:
    v_pk_mul_f32 v[192:193], v[192:193], v[22:23]
    v_pk_mul_f32 v[194:195], v[194:195], v[22:23]
    v_pk_mul_f32 v[196:197], v[196:197], v[22:23]
    v_pk_mul_f32 v[198:199], v[198:199], v[22:23]
    v_pk_mul_f32 v[200:201], v[200:201], v[22:23]
    v_pk_mul_f32 v[202:203], v[202:203], v[22:23]
    v_pk_mul_f32 v[204:205], v[204:205], v[22:23]
    v_pk_mul_f32 v[206:207], v[206:207], v[22:23]
    v_cvt_pk_bf16_f32 v112, v192, v193
    v_cvt_pk_bf16_f32 v113, v194, v195
    v_cvt_pk_bf16_f32 v114, v196, v197
    v_cvt_pk_bf16_f32 v115, v198, v199
    v_cvt_pk_bf16_f32 v116, v200, v201
    v_cvt_pk_bf16_f32 v117, v202, v203
    v_cvt_pk_bf16_f32 v118, v204, v205
    v_cvt_pk_bf16_f32 v119, v206, v207
    buffer_store_dwordx4 v[112:115], v36, s[48:51], s4 offen offset:0 sc1
    buffer_store_dwordx4 v[116:119], v36, s[48:51], s4 offen offset:1024 sc1
    v_pk_mul_f32 v[208:209], v[208:209], v[22:23]
    v_pk_mul_f32 v[210:211], v[210:211], v[22:23]
    v_pk_mul_f32 v[212:213], v[212:213], v[22:23]
    v_pk_mul_f32 v[214:215], v[214:215], v[22:23]
    v_pk_mul_f32 v[216:217], v[216:217], v[22:23]
    v_pk_mul_f32 v[218:219], v[218:219], v[22:23]
    v_pk_mul_f32 v[220:221], v[220:221], v[22:23]
    v_pk_mul_f32 v[222:223], v[222:223], v[22:23]
    v_cvt_pk_bf16_f32 v120, v208, v209
    v_cvt_pk_bf16_f32 v121, v210, v211
    v_cvt_pk_bf16_f32 v122, v212, v213
    v_cvt_pk_bf16_f32 v123, v214, v215
    v_cvt_pk_bf16_f32 v124, v216, v217
    v_cvt_pk_bf16_f32 v125, v218, v219
    v_cvt_pk_bf16_f32 v126, v220, v221
    v_cvt_pk_bf16_f32 v127, v222, v223
    buffer_store_dwordx4 v[120:123], v36, s[48:51], s4 offen offset:2048 sc1
    buffer_store_dwordx4 v[124:127], v36, s[48:51], s4 offen offset:3072 sc1
    v_pk_mul_f32 v[224:225], v[224:225], v[22:23]
    v_pk_mul_f32 v[226:227], v[226:227], v[22:23]
    v_pk_mul_f32 v[228:229], v[228:229], v[22:23]
    v_pk_mul_f32 v[230:231], v[230:231], v[22:23]
    v_pk_mul_f32 v[232:233], v[232:233], v[22:23]
    v_pk_mul_f32 v[234:235], v[234:235], v[22:23]
    v_pk_mul_f32 v[236:237], v[236:237], v[22:23]
    v_pk_mul_f32 v[238:239], v[238:239], v[22:23]
    v_cvt_pk_bf16_f32 v128, v224, v225
    v_cvt_pk_bf16_f32 v129, v226, v227
    v_cvt_pk_bf16_f32 v130, v228, v229
    v_cvt_pk_bf16_f32 v131, v230, v231
    v_cvt_pk_bf16_f32 v132, v232, v233
    v_cvt_pk_bf16_f32 v133, v234, v235
    v_cvt_pk_bf16_f32 v134, v236, v237
    v_cvt_pk_bf16_f32 v135, v238, v239
    buffer_store_dwordx4 v[128:131], v36, s[48:51], s5 offen offset:0 sc1
    buffer_store_dwordx4 v[132:135], v36, s[48:51], s5 offen offset:1024 sc1
    v_pk_mul_f32 v[240:241], v[240:241], v[22:23]
    v_pk_mul_f32 v[242:243], v[242:243], v[22:23]
    v_pk_mul_f32 v[244:245], v[244:245], v[22:23]
    v_pk_mul_f32 v[246:247], v[246:247], v[22:23]
    v_pk_mul_f32 v[248:249], v[248:249], v[22:23]
    v_pk_mul_f32 v[250:251], v[250:251], v[22:23]
    v_pk_mul_f32 v[252:253], v[252:253], v[22:23]
    v_pk_mul_f32 v[254:255], v[254:255], v[22:23]
    v_cvt_pk_bf16_f32 v136, v240, v241
    v_cvt_pk_bf16_f32 v137, v242, v243
    v_cvt_pk_bf16_f32 v138, v244, v245
    v_cvt_pk_bf16_f32 v139, v246, v247
    v_cvt_pk_bf16_f32 v140, v248, v249
    v_cvt_pk_bf16_f32 v141, v250, v251
    v_cvt_pk_bf16_f32 v142, v252, v253
    v_cvt_pk_bf16_f32 v143, v254, v255
    buffer_store_dwordx4 v[136:139], v36, s[48:51], s5 offen offset:2048 sc1
    buffer_store_dwordx4 v[140:143], v36, s[48:51], s5 offen offset:3072 sc1
    s_waitcnt vmcnt(0)
    buffer_store_dword v38, v7, s[48:51], s6 offen sc1
L_P2:
    s_cmp_ge_u32 s3, 4
    s_cbranch_scc1 L_P2IDLE
    v_mov_b32 v192, 0
    v_mov_b32 v193, 0
    v_mov_b32 v194, 0
    v_mov_b32 v195, 0
    v_mov_b32 v196, 0
    v_mov_b32 v197, 0
    v_mov_b32 v198, 0
    v_mov_b32 v199, 0
    v_mov_b32 v200, 0
    v_mov_b32 v201, 0
    v_mov_b32 v202, 0
    v_mov_b32 v203, 0
    v_mov_b32 v204, 0
    v_mov_b32 v205, 0
    v_mov_b32 v206, 0
    v_mov_b32 v207, 0
    v_mov_b32 v208, 0
    v_mov_b32 v209, 0
    v_mov_b32 v210, 0
    v_mov_b32 v211, 0
    v_mov_b32 v212, 0
    v_mov_b32 v213, 0
    v_mov_b32 v214, 0
    v_mov_b32 v215, 0
    v_mov_b32 v216, 0
    v_mov_b32 v217, 0
    v_mov_b32 v218, 0
    v_mov_b32 v219, 0
    v_mov_b32 v220, 0
    v_mov_b32 v221, 0
    v_mov_b32 v222, 0
    v_mov_b32 v223, 0
    v_mov_b32 v224, 0
    v_mov_b32 v225, 0
    v_mov_b32 v226, 0
    v_mov_b32 v227, 0
    v_mov_b32 v228, 0
    v_mov_b32 v229, 0
    v_mov_b32 v230, 0
    v_mov_b32 v231, 0
    v_mov_b32 v232, 0
    v_mov_b32 v233, 0
    v_mov_b32 v234, 0
    v_mov_b32 v235, 0
    v_mov_b32 v236, 0
    v_mov_b32 v237, 0
    v_mov_b32 v238, 0
    v_mov_b32 v239, 0
    v_mov_b32 v240, 0
    v_mov_b32 v241, 0
    v_mov_b32 v242, 0
    v_mov_b32 v243, 0
    v_mov_b32 v244, 0
    v_mov_b32 v245, 0
    v_mov_b32 v246, 0
    v_mov_b32 v247, 0
    v_mov_b32 v248, 0
    v_mov_b32 v249, 0
    v_mov_b32 v250, 0
    v_mov_b32 v251, 0
    v_mov_b32 v252, 0
    v_mov_b32 v253, 0
    v_mov_b32 v254, 0
    v_mov_b32 v255, 0
    v_mov_b32 v72, 0
    v_mov_b32 v73, 0
    v_mov_b32 v74, 0
    v_mov_b32 v75, 0
    v_mov_b32 v76, 0
    v_mov_b32 v77, 0
    v_mov_b32 v78, 0
    v_mov_b32 v79, 0
    v_mov_b32 v80, 0
    v_mov_b32 v81, 0
    v_mov_b32 v82, 0
    v_mov_b32 v83, 0
    v_mov_b32 v84, 0
    v_mov_b32 v85, 0
    v_mov_b32 v86, 0
    v_mov_b32 v87, 0
    v_mov_b32 v88, 0
    v_mov_b32 v89, 0
    v_mov_b32 v90, 0
    v_mov_b32 v91, 0
    v_mov_b32 v92, 0
    v_mov_b32 v93, 0
    v_mov_b32 v94, 0
    v_mov_b32 v95, 0
    v_mov_b32 v96, 0
    v_mov_b32 v97, 0
    v_mov_b32 v98, 0
    v_mov_b32 v99, 0
    v_mov_b32 v100, 0
    v_mov_b32 v101, 0
    v_mov_b32 v102, 0
    v_mov_b32 v103, 0
    v_mov_b32 v120, 0
    v_mov_b32 v121, 0
    v_mov_b32 v122, 0
    v_mov_b32 v123, 0
    v_mov_b32 v124, 0
    v_mov_b32 v125, 0
    v_mov_b32 v126, 0
    v_mov_b32 v127, 0
    v_mov_b32 v128, 0
    v_mov_b32 v129, 0
    v_mov_b32 v130, 0
    v_mov_b32 v131, 0
    v_mov_b32 v132, 0
    v_mov_b32 v133, 0
    v_mov_b32 v134, 0
    v_mov_b32 v135, 0
    v_and_b32 v7, 1, v2
    v_lshlrev_b32 v7, 5, v7
    v_and_b32 v29, 1, v4
    v_lshl_add_u32 v7, v29, 4, v7
    v_lshrrev_b32 v30, 1, v2
    v_lshl_add_u32 v7, v30, 3, v7
    v_lshl_add_u32 v7, v3, 6, v7
    v_mov_b32 v27, 27
    v_mov_b32 v34, 0
    s_mov_b32 s10, 0
    s_cmp_ge_u32 s94, 28
    s_cbranch_scc1 L_P2T2
    v_lshl_add_u32 v10, v5, 10, v7
    s_lshl_b32 s4, s3, 12
    v_add_u32 v11, s4, v36
    s_mov_b32 s86, 49152
    s_mov_b32 s87, 98304
    v_add_u32 v12, s86, v10
    v_add_u32 v13, s87, v11
    v_cmp_gt_i32 vcc, v27, v34
    s_cbranch_vccnz L_SPIN17
L_SRET18:
L_P2LOOP1:
    v_mfma_f32_32x32x16_bf16 v[192:207], v[72:75], v[120:123], v[192:207]
    ds_read_b128 v[104:107], v13 offset:0
    ds_read_b64_tr_b16 v[40:41], v12 offset:0
    ds_read_b64_tr_b16 v[42:43], v12 offset:2048
    v_mfma_f32_32x32x16_bf16 v[208:223], v[76:79], v[120:123], v[208:223]
    ds_read_b64_tr_b16 v[44:45], v12 offset:256
    ds_read_b64_tr_b16 v[46:47], v12 offset:2304
    ds_read_b64_tr_b16 v[48:49], v12 offset:512
    v_mfma_f32_32x32x16_bf16 v[224:239], v[80:83], v[120:123], v[224:239]
    ds_read_b64_tr_b16 v[50:51], v12 offset:2560
    ds_read_b64_tr_b16 v[52:53], v12 offset:768
    ds_read_b64_tr_b16 v[54:55], v12 offset:2816
    v_mfma_f32_32x32x16_bf16 v[240:255], v[84:87], v[120:123], v[240:255]
    ds_read_b128 v[112:115], v13 offset:1024
    ds_read_b64_tr_b16 v[56:57], v12 offset:4096
    ds_read_b64_tr_b16 v[58:59], v12 offset:6144
    v_mfma_f32_32x32x16_bf16 v[192:207], v[88:91], v[128:131], v[192:207]
    ds_read_b64_tr_b16 v[60:61], v12 offset:4352
    ds_read_b64_tr_b16 v[62:63], v12 offset:6400
    ds_read_b64_tr_b16 v[64:65], v12 offset:4608
    v_mfma_f32_32x32x16_bf16 v[208:223], v[92:95], v[128:131], v[208:223]
    ds_read_b64_tr_b16 v[66:67], v12 offset:6656
    ds_read_b64_tr_b16 v[68:69], v12 offset:4864
    ds_read_b64_tr_b16 v[70:71], v12 offset:6912
    v_mfma_f32_32x32x16_bf16 v[224:239], v[96:99], v[128:131], v[224:239]
    ds_read_b128 v[120:123], v13 offset:2048
    ds_read_b64_tr_b16 v[72:73], v12 offset:8192
    ds_read_b64_tr_b16 v[74:75], v12 offset:10240
    v_mfma_f32_32x32x16_bf16 v[240:255], v[100:103], v[128:131], v[240:255]
    ds_read_b64_tr_b16 v[76:77], v12 offset:8448
    ds_read_b64_tr_b16 v[78:79], v12 offset:10496
    ds_read_b64_tr_b16 v[80:81], v12 offset:8704
    s_waitcnt lgkmcnt(15)
    v_mfma_f32_32x32x16_bf16 v[192:207], v[40:43], v[104:107], v[192:207]
    ds_read_b64_tr_b16 v[82:83], v12 offset:10752
    ds_read_b64_tr_b16 v[84:85], v12 offset:8960
    ds_read_b64_tr_b16 v[86:87], v12 offset:11008
    v_mfma_f32_32x32x16_bf16 v[208:223], v[44:47], v[104:107], v[208:223]
    ds_read_b128 v[128:131], v13 offset:3072
    ds_read_b64_tr_b16 v[88:89], v12 offset:12288
    ds_read_b64_tr_b16 v[90:91], v12 offset:14336
    v_mfma_f32_32x32x16_bf16 v[224:239], v[48:51], v[104:107], v[224:239]
    ds_read_b64_tr_b16 v[92:93], v12 offset:12544
    ds_read_b64_tr_b16 v[94:95], v12 offset:14592
    ds_read_b64_tr_b16 v[96:97], v12 offset:12800
    v_mfma_f32_32x32x16_bf16 v[240:255], v[52:55], v[104:107], v[240:255]
    ds_read_b64_tr_b16 v[98:99], v12 offset:14848
    ds_read_b64_tr_b16 v[100:101], v12 offset:13056
    ds_read_b64_tr_b16 v[102:103], v12 offset:15104
    ds_read_b32 v34, v32
    s_waitcnt lgkmcnt(15)
    v_mfma_f32_32x32x16_bf16 v[192:207], v[56:59], v[112:115], v[192:207]
    s_add_u32 s86, s86, 16384
    s_cmp_eq_u32 s86, 81920
    s_cselect_b32 s86, 0, s86
    v_add_u32 v27, 1, v27
    s_add_u32 s10, s10, 1
    v_mfma_f32_32x32x16_bf16 v[208:223], v[60:63], v[112:115], v[208:223]
    s_add_u32 s87, s87, 16384
    s_cmp_eq_u32 s87, 163840
    s_cselect_b32 s87, 98304, s87
    s_cmp_ge_u32 s10, 16
    s_waitcnt lgkmcnt(0)
    s_barrier
    v_mfma_f32_32x32x16_bf16 v[224:239], v[64:67], v[112:115], v[224:239]
    s_cbranch_scc1 L_P2X1
    v_add_u32 v12, s86, v10
    v_add_u32 v13, s87, v11
    v_cmp_gt_i32 vcc, v27, v34
    s_cbranch_vccnz L_SPIN19
L_SRET20:
    v_mfma_f32_32x32x16_bf16 v[240:255], v[68:71], v[112:115], v[240:255]
    s_branch L_P2LOOP1
L_P2X1:
    v_mfma_f32_32x32x16_bf16 v[240:255], v[68:71], v[112:115], v[240:255]
    v_mfma_f32_32x32x16_bf16 v[192:207], v[72:75], v[120:123], v[192:207]
    v_mfma_f32_32x32x16_bf16 v[208:223], v[76:79], v[120:123], v[208:223]
    v_mfma_f32_32x32x16_bf16 v[224:239], v[80:83], v[120:123], v[224:239]
    v_mfma_f32_32x32x16_bf16 v[240:255], v[84:87], v[120:123], v[240:255]
    v_mfma_f32_32x32x16_bf16 v[192:207], v[88:91], v[128:131], v[192:207]
    v_mfma_f32_32x32x16_bf16 v[208:223], v[92:95], v[128:131], v[208:223]
    v_mfma_f32_32x32x16_bf16 v[224:239], v[96:99], v[128:131], v[224:239]
    v_mfma_f32_32x32x16_bf16 v[240:255], v[100:103], v[128:131], v[240:255]
    s_branch L_XCH
L_P2T2:
    v_lshl_add_u32 v10, v5, 9, v7
    s_lshl_b32 s4, s3, 13
    v_add_u32 v11, s4, v36
    s_mov_b32 s86, 155648
    s_mov_b32 s87, 0
    v_add_u32 v12, s86, v10
    v_add_u32 v13, s87, v11
    v_cmp_gt_i32 vcc, v27, v34
    s_cbranch_vccnz L_SPIN21
L_SRET22:
L_P2LOOP2:
    v_mfma_f32_32x32x16_bf16 v[192:207], v[72:75], v[120:123], v[192:207]
    ds_read_b128 v[104:107], v13 offset:0
    ds_read_b64_tr_b16 v[40:41], v12 offset:0
    ds_read_b64_tr_b16 v[42:43], v12 offset:1024
    v_mfma_f32_32x32x16_bf16 v[208:223], v[76:79], v[120:123], v[208:223]
    ds_read_b64_tr_b16 v[44:45], v12 offset:256
    ds_read_b64_tr_b16 v[46:47], v12 offset:1280
    ds_read_b128 v[108:111], v13 offset:4096
    v_mfma_f32_32x32x16_bf16 v[224:239], v[72:75], v[124:127], v[224:239]
    ds_read_b128 v[112:115], v13 offset:1024
    ds_read_b64_tr_b16 v[56:57], v12 offset:2048
    v_mfma_f32_32x32x16_bf16 v[240:255], v[76:79], v[124:127], v[240:255]
    v_mfma_f32_32x32x16_bf16 v[192:207], v[88:91], v[128:131], v[192:207]
    ds_read_b64_tr_b16 v[58:59], v12 offset:3072
    ds_read_b64_tr_b16 v[60:61], v12 offset:2304
    ds_read_b64_tr_b16 v[62:63], v12 offset:3328
    v_mfma_f32_32x32x16_bf16 v[208:223], v[92:95], v[128:131], v[208:223]
    ds_read_b128 v[116:119], v13 offset:5120
    ds_read_b128 v[120:123], v13 offset:2048
    ds_read_b64_tr_b16 v[72:73], v12 offset:4096
    v_mfma_f32_32x32x16_bf16 v[224:239], v[88:91], v[132:135], v[224:239]
    ds_read_b64_tr_b16 v[74:75], v12 offset:5120
    ds_read_b64_tr_b16 v[76:77], v12 offset:4352
    v_mfma_f32_32x32x16_bf16 v[240:255], v[92:95], v[132:135], v[240:255]
    s_waitcnt lgkmcnt(13)
    v_mfma_f32_32x32x16_bf16 v[192:207], v[40:43], v[104:107], v[192:207]
    ds_read_b64_tr_b16 v[78:79], v12 offset:5376
    ds_read_b128 v[124:127], v13 offset:6144
    ds_read_b128 v[128:131], v13 offset:3072
    s_waitcnt lgkmcnt(14)
    v_mfma_f32_32x32x16_bf16 v[208:223], v[44:47], v[104:107], v[208:223]
    ds_read_b64_tr_b16 v[88:89], v12 offset:6144
    ds_read_b64_tr_b16 v[90:91], v12 offset:7168
    ds_read_b64_tr_b16 v[92:93], v12 offset:6400
    s_waitcnt lgkmcnt(15)
    v_mfma_f32_32x32x16_bf16 v[224:239], v[40:43], v[108:111], v[224:239]
    ds_read_b64_tr_b16 v[94:95], v12 offset:7424
    ds_read_b128 v[132:135], v13 offset:7168
    ds_read_b32 v34, v32
    v_mfma_f32_32x32x16_bf16 v[240:255], v[44:47], v[108:111], v[240:255]
    s_waitcnt lgkmcnt(15)
    v_mfma_f32_32x32x16_bf16 v[192:207], v[56:59], v[112:115], v[192:207]
    s_sub_u32 s86, s86, 8192
    s_cmp_eq_u32 s86, 90112
    s_cselect_b32 s86, 155648, s86
    v_add_u32 v27, 1, v27
    s_add_u32 s10, s10, 1
    s_waitcnt lgkmcnt(14)
    v_mfma_f32_32x32x16_bf16 v[208:223], v[60:63], v[112:115], v[208:223]
    s_add_u32 s87, s87, 28672
    s_cmp_eq_u32 s87, 86016
    s_cselect_b32 s87, 0, s87
    s_cmp_ge_u32 s10, 16
    s_waitcnt lgkmcnt(0)
    s_barrier
    v_mfma_f32_32x32x16_bf16 v[224:239], v[56:59], v[116:119], v[224:239]
    s_cbranch_scc1 L_P2X2
    v_add_u32 v12, s86, v10
    v_add_u32 v13, s87, v11
    v_cmp_gt_i32 vcc, v27, v34
    s_cbranch_vccnz L_SPIN23
L_SRET24:
    v_mfma_f32_32x32x16_bf16 v[240:255], v[60:63], v[116:119], v[240:255]
    s_branch L_P2LOOP2
L_P2X2:
    v_mfma_f32_32x32x16_bf16 v[240:255], v[60:63], v[116:119], v[240:255]
    v_mfma_f32_32x32x16_bf16 v[192:207], v[72:75], v[120:123], v[192:207]
    v_mfma_f32_32x32x16_bf16 v[208:223], v[76:79], v[120:123], v[208:223]
    v_mfma_f32_32x32x16_bf16 v[224:239], v[72:75], v[124:127], v[224:239]
    v_mfma_f32_32x32x16_bf16 v[240:255], v[76:79], v[124:127], v[240:255]
    v_mfma_f32_32x32x16_bf16 v[192:207], v[88:91], v[128:131], v[192:207]
    v_mfma_f32_32x32x16_bf16 v[208:223], v[92:95], v[128:131], v[208:223]
    v_mfma_f32_32x32x16_bf16 v[224:239], v[88:91], v[132:135], v[224:239]
    v_mfma_f32_32x32x16_bf16 v[240:255], v[92:95], v[132:135], v[240:255]
L_XCH:
    s_cmp_eq_u32 s3, s93
    s_cbranch_scc1 L_OWN
    s_lshl_b32 s4, s95, 2
    s_add_u32 s4, s4, s3
    s_lshl_b32 s5, s4, 7
    s_lshl_b32 s4, s4, 2
    s_add_u32 s4, s4, s93
    s_lshl_b32 s4, s4, 14
    s_add_u32 s4, s4, 41943040
    v_cvt_pk_bf16_f32 v192, v192, v193
    v_cvt_pk_bf16_f32 v193, v194, v195
    v_cvt_pk_bf16_f32 v194, v196, v197
    v_cvt_pk_bf16_f32 v195, v198, v199
    v_cvt_pk_bf16_f32 v196, v200, v201
    v_cvt_pk_bf16_f32 v197, v202, v203
    v_cvt_pk_bf16_f32 v198, v204, v205
    v_cvt_pk_bf16_f32 v199, v206, v207
    buffer_store_dwordx4 v[192:195], v36, s[48:51], s4 offen offset:0 sc1
    buffer_store_dwordx4 v[196:199], v36, s[48:51], s4 offen offset:1024 sc1
    s_add_u32 s4, s4, 4096
    v_cvt_pk_bf16_f32 v208, v208, v209
    v_cvt_pk_bf16_f32 v209, v210, v211
    v_cvt_pk_bf16_f32 v210, v212, v213
    v_cvt_pk_bf16_f32 v211, v214, v215
    v_cvt_pk_bf16_f32 v212, v216, v217
    v_cvt_pk_bf16_f32 v213, v218, v219
    v_cvt_pk_bf16_f32 v214, v220, v221
    v_cvt_pk_bf16_f32 v215, v222, v223
    buffer_store_dwordx4 v[208:211], v36, s[48:51], s4 offen offset:0 sc1
    buffer_store_dwordx4 v[212:215], v36, s[48:51], s4 offen offset:1024 sc1
    s_add_u32 s4, s4, 4096
    v_cvt_pk_bf16_f32 v224, v224, v225
    v_cvt_pk_bf16_f32 v225, v226, v227
    v_cvt_pk_bf16_f32 v226, v228, v229
    v_cvt_pk_bf16_f32 v227, v230, v231
    v_cvt_pk_bf16_f32 v228, v232, v233
    v_cvt_pk_bf16_f32 v229, v234, v235
    v_cvt_pk_bf16_f32 v230, v236, v237
    v_cvt_pk_bf16_f32 v231, v238, v239
    buffer_store_dwordx4 v[224:227], v36, s[48:51], s4 offen offset:0 sc1
    buffer_store_dwordx4 v[228:231], v36, s[48:51], s4 offen offset:1024 sc1
    s_add_u32 s4, s4, 4096
    v_cvt_pk_bf16_f32 v240, v240, v241
    v_cvt_pk_bf16_f32 v241, v242, v243
    v_cvt_pk_bf16_f32 v242, v244, v245
    v_cvt_pk_bf16_f32 v243, v246, v247
    v_cvt_pk_bf16_f32 v244, v248, v249
    v_cvt_pk_bf16_f32 v245, v250, v251
    v_cvt_pk_bf16_f32 v246, v252, v253
    v_cvt_pk_bf16_f32 v247, v254, v255
    buffer_store_dwordx4 v[240:243], v36, s[48:51], s4 offen offset:0 sc1
    buffer_store_dwordx4 v[244:247], v36, s[48:51], s4 offen offset:1024 sc1
    s_lshl_b32 s4, s93, 2
    s_add_u32 s4, s4, s5
    s_add_u32 s4, s4, 34668544
    v_mov_b32 v7, 0
    s_waitcnt vmcnt(0)
    buffer_store_dword v38, v7, s[48:51], s4 offen sc1
    s_endpgm
L_OWN:
    ds_write_b128 v36, v[192:195] offset:0
    ds_write_b128 v36, v[196:199] offset:1024
    ds_write_b128 v36, v[200:203] offset:2048
    ds_write_b128 v36, v[204:207] offset:3072
    ds_write_b128 v36, v[208:211] offset:4096
    ds_write_b128 v36, v[212:215] offset:5120
    ds_write_b128 v36, v[216:219] offset:6144
    ds_write_b128 v36, v[220:223] offset:7168
    ds_write_b128 v36, v[224:227] offset:8192
    ds_write_b128 v36, v[228:231] offset:9216
    ds_write_b128 v36, v[232:235] offset:10240
    ds_write_b128 v36, v[236:239] offset:11264
    ds_write_b128 v36, v[240:243] offset:12288
    ds_write_b128 v36, v[244:247] offset:13312
    ds_write_b128 v36, v[248:251] offset:14336
    ds_write_b128 v36, v[252:255] offset:15360
    v_mov_b32 v35, 60
    ds_write_b32 v33, v35
    s_waitcnt lgkmcnt(0)
    s_endpgm
L_P2IDLE:
    s_barrier
    s_barrier
    s_barrier
    s_barrier
    s_barrier
    s_barrier
    s_barrier
    s_barrier
    s_barrier
    s_barrier
    s_barrier
    s_barrier
    s_barrier
    s_barrier
    s_barrier
    s_barrier
L_FINAL:
    s_sub_u32 s14, s3, 4
    s_lshl_b32 s4, s95, 2
    s_add_u32 s4, s4, s93
    s_lshl_b32 s5, s4, 7
    s_add_u32 s5, s5, 34668544
    s_lshl_b32 s4, s4, 16
    s_lshl_b32 s6, s14, 12
    s_add_u32 s4, s4, s6
    s_add_u32 s4, s4, 41943040
    v_lshlrev_b32 v7, 2, v2
    v_cmp_ne_u32 s[86:87], s93, v2
    s_lshl_b32 s6, s93, 8
    s_add_u32 s6, s6, 90368
    v_mov_b32 v30, s6
L_FP1:
    buffer_load_dword v29, v7, s[48:51], s5 offen sc1
    s_waitcnt vmcnt(0)
    v_cmp_ne_u32 vcc, v38, v29
    s_nop 0
    s_and_b64 vcc, vcc, s[86:87]
    s_cbranch_vccz L_GO
    s_sleep 2
    s_add_u32 s84, s84, 1
    s_cmp_lt_u32 s84, 2097152
    s_cbranch_scc1 L_FP1
    s_endpgm
L_GO:
    s_add_u32 s6, s93, 1
    s_and_b32 s6, s6, 3
    s_lshl_b32 s6, s6, 14
    s_add_u32 s6, s6, s4
    buffer_load_dwordx4 v[80:83], v36, s[48:51], s6 offen offset:0 sc1
    buffer_load_dwordx4 v[84:87], v36, s[48:51], s6 offen offset:1024 sc1
    s_add_u32 s6, s93, 2
    s_and_b32 s6, s6, 3
    s_lshl_b32 s6, s6, 14
    s_add_u32 s6, s6, s4
    buffer_load_dwordx4 v[96:99], v36, s[48:51], s6 offen offset:0 sc1
    buffer_load_dwordx4 v[100:103], v36, s[48:51], s6 offen offset:1024 sc1
    s_add_u32 s6, s93, 3
    s_and_b32 s6, s6, 3
    s_lshl_b32 s6, s6, 14
    s_add_u32 s6, s6, s4
    buffer_load_dwordx4 v[112:115], v36, s[48:51], s6 offen offset:0 sc1
    buffer_load_dwordx4 v[116:119], v36, s[48:51], s6 offen offset:1024 sc1
L_FW1:
    ds_read_b32 v29, v30
    s_waitcnt lgkmcnt(0)
    v_cmp_gt_u32 vcc, 60, v29
    s_cbranch_vccz L_FW2
    s_add_u32 s84, s84, 1
    s_cmp_lt_u32 s84, 2097152
    s_cbranch_scc1 L_FW1
    s_endpgm
L_FW2:
    s_lshl_b32 s6, s14, 12
    v_add_u32 v30, s6, v36
    ds_read_b128 v[192:195], v30 offset:0
    ds_read_b128 v[196:199], v30 offset:1024
    ds_read_b128 v[200:203], v30 offset:2048
    ds_read_b128 v[204:207], v30 offset:3072
    s_movk_i32 s5, 1152
    v_mul_lo_u32 v7, v6, s5
    v_lshl_add_u32 v7, v5, 5, v7
    s_lshl_b32 s4, s93, 1
    s_lshr_b32 s5, s14, 1
    s_add_u32 s4, s4, s5
    s_and_b32 s6, s14, 1
    s_cmp_ge_u32 s94, 28
    s_cselect_b32 s4, s4, s93
    s_cselect_b32 s6, s6, s14
    s_cmp_ge_u32 s4, 7
    s_cbranch_scc1 L_FIN
    s_add_u32 s4, s4, s96
    s_and_b32 s5, s2, 1
    s_mul_i32 s5, s5, 28
    s_add_u32 s4, s4, s5
    s_mul_i32 s4, s4, 36864
    s_lshl_b32 s6, s6, 6
    s_add_u32 s4, s4, s6
    s_add_u32 s4, s4, s97
    s_waitcnt vmcnt(0)
    v_lshlrev_b32 v208, 16, v80
    v_and_b32 v209, 0xffff0000, v80
    v_lshlrev_b32 v210, 16, v81
    v_and_b32 v211, 0xffff0000, v81
    v_lshlrev_b32 v212, 16, v82
    v_and_b32 v213, 0xffff0000, v82
    v_lshlrev_b32 v214, 16, v83
    v_and_b32 v215, 0xffff0000, v83
    v_lshlrev_b32 v216, 16, v84
    v_and_b32 v217, 0xffff0000, v84
    v_lshlrev_b32 v218, 16, v85
    v_and_b32 v219, 0xffff0000, v85
    v_lshlrev_b32 v220, 16, v86
    v_and_b32 v221, 0xffff0000, v86
    v_lshlrev_b32 v222, 16, v87
    v_and_b32 v223, 0xffff0000, v87
    v_lshlrev_b32 v224, 16, v96
    v_and_b32 v225, 0xffff0000, v96
    v_lshlrev_b32 v226, 16, v97
    v_and_b32 v227, 0xffff0000, v97
    v_lshlrev_b32 v228, 16, v98
    v_and_b32 v229, 0xffff0000, v98
    v_lshlrev_b32 v230, 16, v99
    v_and_b32 v231, 0xffff0000, v99
    v_lshlrev_b32 v232, 16, v100
    v_and_b32 v233, 0xffff0000, v100
    v_lshlrev_b32 v234, 16, v101
    v_and_b32 v235, 0xffff0000, v101
    v_lshlrev_b32 v236, 16, v102
    v_and_b32 v237, 0xffff0000, v102
    v_lshlrev_b32 v238, 16, v103
    v_and_b32 v239, 0xffff0000, v103
    v_lshlrev_b32 v240, 16, v112
    v_and_b32 v241, 0xffff0000, v112
    v_lshlrev_b32 v242, 16, v113
    v_and_b32 v243, 0xffff0000, v113
    v_lshlrev_b32 v244, 16, v114
    v_and_b32 v245, 0xffff0000, v114
    v_lshlrev_b32 v246, 16, v115
    v_and_b32 v247, 0xffff0000, v115
    v_lshlrev_b32 v248, 16, v116
    v_and_b32 v249, 0xffff0000, v116
    v_lshlrev_b32 v250, 16, v117
    v_and_b32 v251, 0xffff0000, v117
    v_lshlrev_b32 v252, 16, v118
    v_and_b32 v253, 0xffff0000, v118
    v_lshlrev_b32 v254, 16, v119
    v_and_b32 v255, 0xffff0000, v119
    s_waitcnt lgkmcnt(3)
    v_add_f32 v192, v192, v208
    v_add_f32 v224, v224, v240
    v_add_f32 v193, v193, v209
    v_add_f32 v225, v225, v241
    v_add_f32 v194, v194, v210
    v_add_f32 v226, v226, v242
    v_add_f32 v195, v195, v211
    v_add_f32 v227, v227, v243
    s_waitcnt lgkmcnt(2)
    v_add_f32 v196, v196, v212
    v_add_f32 v228, v228, v244
    v_add_f32 v197, v197, v213
    v_add_f32 v229, v229, v245
    v_add_f32 v198, v198, v214
    v_add_f32 v230, v230, v246
    v_add_f32 v199, v199, v215
    v_add_f32 v231, v231, v247
    s_waitcnt lgkmcnt(1)
    v_add_f32 v200, v200, v216
    v_add_f32 v232, v232, v248
    v_add_f32 v201, v201, v217
    v_add_f32 v233, v233, v249
    v_add_f32 v202, v202, v218
    v_add_f32 v234, v234, v250
    v_add_f32 v203, v203, v219
    v_add_f32 v235, v235, v251
    s_waitcnt lgkmcnt(0)
    v_add_f32 v204, v204, v220
    v_add_f32 v236, v236, v252
    v_add_f32 v205, v205, v221
    v_add_f32 v237, v237, v253
    v_add_f32 v206, v206, v222
    v_add_f32 v238, v238, v254
    v_add_f32 v207, v207, v223
    v_add_f32 v239, v239, v255
    v_add_f32 v192, v192, v224
    v_add_f32 v193, v193, v225
    v_add_f32 v194, v194, v226
    v_add_f32 v195, v195, v227
    v_add_f32 v196, v196, v228
    v_add_f32 v197, v197, v229
    v_add_f32 v198, v198, v230
    v_add_f32 v199, v199, v231
    v_add_f32 v200, v200, v232
    v_add_f32 v201, v201, v233
    v_add_f32 v202, v202, v234
    v_add_f32 v203, v203, v235
    v_add_f32 v204, v204, v236
    v_add_f32 v205, v205, v237
    v_add_f32 v206, v206, v238
    v_add_f32 v207, v207, v239
    v_cvt_pk_bf16_f32 v40, v192, v193
    v_cvt_pk_bf16_f32 v41, v194, v195
    v_cvt_pk_bf16_f32 v42, v196, v197
    v_cvt_pk_bf16_f32 v43, v198, v199
    v_cvt_pk_bf16_f32 v44, v200, v201
    v_cvt_pk_bf16_f32 v45, v202, v203
    v_cvt_pk_bf16_f32 v46, v204, v205
    v_cvt_pk_bf16_f32 v47, v206, v207
    buffer_store_dwordx4 v[40:43], v7, s[56:59], s4 offen
    buffer_store_dwordx4 v[44:47], v7, s[56:59], s4 offen offset:16
L_FIN:
    s_endpgm
L_RARE11:
    v_cmp_lt_f32 vcc, s88, v24
    s_cbranch_vccz L_RARE11F
    s_nop 15
    s_nop 15
    v_mov_b32 v25, v24
    s_nop 1
    v_permlane32_swap_b32 v24, v25
    s_nop 1
    v_max3_f32 v24, v24, v25, 0
    v_exp_f32 v25, -v24
    v_sub_f32 v176, v176, v24
    v_sub_f32 v144, v144, v24
    v_sub_f32 v177, v177, v24
    v_sub_f32 v145, v145, v24
    v_sub_f32 v178, v178, v24
    v_sub_f32 v146, v146, v24
    v_sub_f32 v179, v179, v24
    v_sub_f32 v147, v147, v24
    v_sub_f32 v180, v180, v24
    v_sub_f32 v148, v148, v24
    v_sub_f32 v181, v181, v24
    v_sub_f32 v149, v149, v24
    v_sub_f32 v182, v182, v24
    v_sub_f32 v150, v150, v24
    v_sub_f32 v183, v183, v24
    v_sub_f32 v151, v151, v24
    v_sub_f32 v184, v184, v24
    v_sub_f32 v152, v152, v24
    v_sub_f32 v185, v185, v24
    v_sub_f32 v153, v153, v24
    v_sub_f32 v186, v186, v24
    v_sub_f32 v154, v154, v24
    v_sub_f32 v187, v187, v24
    v_sub_f32 v155, v155, v24
    v_sub_f32 v188, v188, v24
    v_sub_f32 v156, v156, v24
    v_sub_f32 v189, v189, v24
    v_sub_f32 v157, v157, v24
    v_sub_f32 v190, v190, v24
    v_sub_f32 v158, v158, v24
    v_sub_f32 v191, v191, v24
    v_sub_f32 v159, v159, v24
    v_mul_f32 v22, v22, v25
    v_mul_f32 v23, v23, v25
    v_mul_f32 v192, v192, v25
    v_mul_f32 v193, v193, v25
    v_mul_f32 v194, v194, v25
    v_mul_f32 v195, v195, v25
    v_mul_f32 v196, v196, v25
    v_mul_f32 v197, v197, v25
    v_mul_f32 v198, v198, v25
    v_mul_f32 v199, v199, v25
    v_mul_f32 v200, v200, v25
    v_mul_f32 v201, v201, v25
    v_mul_f32 v202, v202, v25
    v_mul_f32 v203, v203, v25
    v_mul_f32 v204, v204, v25
    v_mul_f32 v205, v205, v25
    v_mul_f32 v206, v206, v25
    v_mul_f32 v207, v207, v25
    v_mul_f32 v208, v208, v25
    v_mul_f32 v209, v209, v25
    v_mul_f32 v210, v210, v25
    v_mul_f32 v211, v211, v25
    v_mul_f32 v212, v212, v25
    v_mul_f32 v213, v213, v25
    v_mul_f32 v214, v214, v25
    v_mul_f32 v215, v215, v25
    v_mul_f32 v216, v216, v25
    v_mul_f32 v217, v217, v25
    v_mul_f32 v218, v218, v25
    v_mul_f32 v219, v219, v25
    v_mul_f32 v220, v220, v25
    v_mul_f32 v221, v221, v25
    v_mul_f32 v222, v222, v25
    v_mul_f32 v223, v223, v25
    v_mul_f32 v224, v224, v25
    v_mul_f32 v225, v225, v25
    v_mul_f32 v226, v226, v25
    v_mul_f32 v227, v227, v25
    v_mul_f32 v228, v228, v25
    v_mul_f32 v229, v229, v25
    v_mul_f32 v230, v230, v25
    v_mul_f32 v231, v231, v25
    v_mul_f32 v232, v232, v25
    v_mul_f32 v233, v233, v25
    v_mul_f32 v234, v234, v25
    v_mul_f32 v235, v235, v25
    v_mul_f32 v236, v236, v25
    v_mul_f32 v237, v237, v25
    v_mul_f32 v238, v238, v25
    v_mul_f32 v239, v239, v25
    v_mul_f32 v240, v240, v25
    v_mul_f32 v241, v241, v25
    v_mul_f32 v242, v242, v25
    v_mul_f32 v243, v243, v25
    v_mul_f32 v244, v244, v25
    v_mul_f32 v245, v245, v25
    v_mul_f32 v246, v246, v25
    v_mul_f32 v247, v247, v25
    v_mul_f32 v248, v248, v25
    v_mul_f32 v249, v249, v25
    v_mul_f32 v250, v250, v25
    v_mul_f32 v251, v251, v25
    v_mul_f32 v252, v252, v25
    v_mul_f32 v253, v253, v25
    v_mul_f32 v254, v254, v25
    v_mul_f32 v255, v255, v25
    s_nop 3
    s_branch L_RARE11F
L_RARE13:
    v_cmp_lt_f32 vcc, s88, v24
    s_cbranch_vccz L_RARE13F
    s_nop 15
    s_nop 15
    v_mov_b32 v25, v24
    s_nop 1
    v_permlane32_swap_b32 v24, v25
    s_nop 1
    v_max3_f32 v24, v24, v25, 0
    v_exp_f32 v25, -v24
    v_sub_f32 v160, v160, v24
    v_sub_f32 v144, v144, v24
    v_sub_f32 v161, v161, v24
    v_sub_f32 v145, v145, v24
    v_sub_f32 v162, v162, v24
    v_sub_f32 v146, v146, v24
    v_sub_f32 v163, v163, v24
    v_sub_f32 v147, v147, v24
    v_sub_f32 v164, v164, v24
    v_sub_f32 v148, v148, v24
    v_sub_f32 v165, v165, v24
    v_sub_f32 v149, v149, v24
    v_sub_f32 v166, v166, v24
    v_sub_f32 v150, v150, v24
    v_sub_f32 v167, v167, v24
    v_sub_f32 v151, v151, v24
    v_sub_f32 v168, v168, v24
    v_sub_f32 v152, v152, v24
    v_sub_f32 v169, v169, v24
    v_sub_f32 v153, v153, v24
    v_sub_f32 v170, v170, v24
    v_sub_f32 v154, v154, v24
    v_sub_f32 v171, v171, v24
    v_sub_f32 v155, v155, v24
    v_sub_f32 v172, v172, v24
    v_sub_f32 v156, v156, v24
    v_sub_f32 v173, v173, v24
    v_sub_f32 v157, v157, v24
    v_sub_f32 v174, v174, v24
    v_sub_f32 v158, v158, v24
    v_sub_f32 v175, v175, v24
    v_sub_f32 v159, v159, v24
    v_mul_f32 v22, v22, v25
    v_mul_f32 v23, v23, v25
    v_mul_f32 v192, v192, v25
    v_mul_f32 v193, v193, v25
    v_mul_f32 v194, v194, v25
    v_mul_f32 v195, v195, v25
    v_mul_f32 v196, v196, v25
    v_mul_f32 v197, v197, v25
    v_mul_f32 v198, v198, v25
    v_mul_f32 v199, v199, v25
    v_mul_f32 v200, v200, v25
    v_mul_f32 v201, v201, v25
    v_mul_f32 v202, v202, v25
    v_mul_f32 v203, v203, v25
    v_mul_f32 v204, v204, v25
    v_mul_f32 v205, v205, v25
    v_mul_f32 v206, v206, v25
    v_mul_f32 v207, v207, v25
    v_mul_f32 v208, v208, v25
    v_mul_f32 v209, v209, v25
    v_mul_f32 v210, v210, v25
    v_mul_f32 v211, v211, v25
    v_mul_f32 v212, v212, v25
    v_mul_f32 v213, v213, v25
    v_mul_f32 v214, v214, v25
    v_mul_f32 v215, v215, v25
    v_mul_f32 v216, v216, v25
    v_mul_f32 v217, v217, v25
    v_mul_f32 v218, v218, v25
    v_mul_f32 v219, v219, v25
    v_mul_f32 v220, v220, v25
    v_mul_f32 v221, v221, v25
    v_mul_f32 v222, v222, v25
    v_mul_f32 v223, v223, v25
    v_mul_f32 v224, v224, v25
    v_mul_f32 v225, v225, v25
    v_mul_f32 v226, v226, v25
    v_mul_f32 v227, v227, v25
    v_mul_f32 v228, v228, v25
    v_mul_f32 v229, v229, v25
    v_mul_f32 v230, v230, v25
    v_mul_f32 v231, v231, v25
    v_mul_f32 v232, v232, v25
    v_mul_f32 v233, v233, v25
    v_mul_f32 v234, v234, v25
    v_mul_f32 v235, v235, v25
    v_mul_f32 v236, v236, v25
    v_mul_f32 v237, v237, v25
    v_mul_f32 v238, v238, v25
    v_mul_f32 v239, v239, v25
    v_mul_f32 v240, v240, v25
    v_mul_f32 v241, v241, v25
    v_mul_f32 v242, v242, v25
    v_mul_f32 v243, v243, v25
    v_mul_f32 v244, v244, v25
    v_mul_f32 v245, v245, v25
    v_mul_f32 v246, v246, v25
    v_mul_f32 v247, v247, v25
    v_mul_f32 v248, v248, v25
    v_mul_f32 v249, v249, v25
    v_mul_f32 v250, v250, v25
    v_mul_f32 v251, v251, v25
    v_mul_f32 v252, v252, v25
    v_mul_f32 v253, v253, v25
    v_mul_f32 v254, v254, v25
    v_mul_f32 v255, v255, v25
    s_nop 3
    s_branch L_RARE13F
L_RARE15:
    v_cmp_lt_f32 vcc, s88, v24
    s_cbranch_vccz L_RARE15F
    s_nop 15
    s_nop 15
    v_mov_b32 v25, v24
    s_nop 1
    v_permlane32_swap_b32 v24, v25
    s_nop 1
    v_max3_f32 v24, v24, v25, 0
    v_exp_f32 v25, -v24
    v_sub_f32 v176, v176, v24
    v_sub_f32 v144, v144, v24
    v_sub_f32 v177, v177, v24
    v_sub_f32 v145, v145, v24
    v_sub_f32 v178, v178, v24
    v_sub_f32 v146, v146, v24
    v_sub_f32 v179, v179, v24
    v_sub_f32 v147, v147, v24
    v_sub_f32 v180, v180, v24
    v_sub_f32 v148, v148, v24
    v_sub_f32 v181, v181, v24
    v_sub_f32 v149, v149, v24
    v_sub_f32 v182, v182, v24
    v_sub_f32 v150, v150, v24
    v_sub_f32 v183, v183, v24
    v_sub_f32 v151, v151, v24
    v_sub_f32 v184, v184, v24
    v_sub_f32 v152, v152, v24
    v_sub_f32 v185, v185, v24
    v_sub_f32 v153, v153, v24
    v_sub_f32 v186, v186, v24
    v_sub_f32 v154, v154, v24
    v_sub_f32 v187, v187, v24
    v_sub_f32 v155, v155, v24
    v_sub_f32 v188, v188, v24
    v_sub_f32 v156, v156, v24
    v_sub_f32 v189, v189, v24
    v_sub_f32 v157, v157, v24
    v_sub_f32 v190, v190, v24
    v_sub_f32 v158, v158, v24
    v_sub_f32 v191, v191, v24
    v_sub_f32 v159, v159, v24
    v_mul_f32 v22, v22, v25
    v_mul_f32 v23, v23, v25
    v_mul_f32 v192, v192, v25
    v_mul_f32 v193, v193, v25
    v_mul_f32 v194, v194, v25
    v_mul_f32 v195, v195, v25
    v_mul_f32 v196, v196, v25
    v_mul_f32 v197, v197, v25
    v_mul_f32 v198, v198, v25
    v_mul_f32 v199, v199, v25
    v_mul_f32 v200, v200, v25
    v_mul_f32 v201, v201, v25
    v_mul_f32 v202, v202, v25
    v_mul_f32 v203, v203, v25
    v_mul_f32 v204, v204, v25
    v_mul_f32 v205, v205, v25
    v_mul_f32 v206, v206, v25
    v_mul_f32 v207, v207, v25
    v_mul_f32 v208, v208, v25
    v_mul_f32 v209, v209, v25
    v_mul_f32 v210, v210, v25
    v_mul_f32 v211, v211, v25
    v_mul_f32 v212, v212, v25
    v_mul_f32 v213, v213, v25
    v_mul_f32 v214, v214, v25
    v_mul_f32 v215, v215, v25
    v_mul_f32 v216, v216, v25
    v_mul_f32 v217, v217, v25
    v_mul_f32 v218, v218, v25
    v_mul_f32 v219, v219, v25
    v_mul_f32 v220, v220, v25
    v_mul_f32 v221, v221, v25
    v_mul_f32 v222, v222, v25
    v_mul_f32 v223, v223, v25
    v_mul_f32 v224, v224, v25
    v_mul_f32 v225, v225, v25
    v_mul_f32 v226, v226, v25
    v_mul_f32 v227, v227, v25
    v_mul_f32 v228, v228, v25
    v_mul_f32 v229, v229, v25
    v_mul_f32 v230, v230, v25
    v_mul_f32 v231, v231, v25
    v_mul_f32 v232, v232, v25
    v_mul_f32 v233, v233, v25
    v_mul_f32 v234, v234, v25
    v_mul_f32 v235, v235, v25
    v_mul_f32 v236, v236, v25
    v_mul_f32 v237, v237, v25
    v_mul_f32 v238, v238, v25
    v_mul_f32 v239, v239, v25
    v_mul_f32 v240, v240, v25
    v_mul_f32 v241, v241, v25
    v_mul_f32 v242, v242, v25
    v_mul_f32 v243, v243, v25
    v_mul_f32 v244, v244, v25
    v_mul_f32 v245, v245, v25
    v_mul_f32 v246, v246, v25
    v_mul_f32 v247, v247, v25
    v_mul_f32 v248, v248, v25
    v_mul_f32 v249, v249, v25
    v_mul_f32 v250, v250, v25
    v_mul_f32 v251, v251, v25
    v_mul_f32 v252, v252, v25
    v_mul_f32 v253, v253, v25
    v_mul_f32 v254, v254, v25
    v_mul_f32 v255, v255, v25
    s_nop 3
    s_branch L_RARE15F
L_SPIN1:
    ds_read_b32 v34, v32
    s_waitcnt lgkmcnt(0)
    v_cmp_gt_i32 vcc, v27, v34
    s_cbranch_vccz L_SRET2
    s_sleep 1
    s_add_u32 s84, s84, 1
    s_cmp_lt_u32 s84, 2097152
    s_cbranch_scc1 L_SPIN1
    s_endpgm
L_SPIN3:
    ds_read_b32 v34, v32
    s_waitcnt lgkmcnt(0)
    v_cmp_gt_i32 vcc, v27, v34
    s_cbranch_vccz L_SRET4
    s_sleep 1
    s_add_u32 s84, s84, 1
    s_cmp_lt_u32 s84, 2097152
    s_cbranch_scc1 L_SPIN3
    s_endpgm
L_SPIN5:
    ds_read_b32 v34, v32
    s_waitcnt lgkmcnt(0)
    v_cmp_gt_i32 vcc, v27, v34
    s_cbranch_vccz L_SRET6
    s_sleep 1
    s_add_u32 s84, s84, 1
    s_cmp_lt_u32 s84, 2097152
    s_cbranch_scc1 L_SPIN5
    s_endpgm
L_SPIN7:
    ds_read_b32 v34, v32
    s_waitcnt lgkmcnt(0)
    v_cmp_gt_i32 vcc, v27, v34
    s_cbranch_vccz L_SRET8
    s_sleep 1
    s_add_u32 s84, s84, 1
    s_cmp_lt_u32 s84, 2097152
    s_cbranch_scc1 L_SPIN7
    s_endpgm
L_SPIN9:
    ds_read_b32 v34, v32
    s_waitcnt lgkmcnt(0)
    v_cmp_gt_i32 vcc, v27, v34
    s_cbranch_vccz L_SRET10
    s_sleep 1
    s_add_u32 s84, s84, 1
    s_cmp_lt_u32 s84, 2097152
    s_cbranch_scc1 L_SPIN9
    s_endpgm
L_SPIN17:
    ds_read_b32 v34, v32
    s_waitcnt lgkmcnt(0)
    v_cmp_gt_i32 vcc, v27, v34
    s_cbranch_vccz L_SRET18
    s_sleep 1
    s_add_u32 s84, s84, 1
    s_cmp_lt_u32 s84, 2097152
    s_cbranch_scc1 L_SPIN17
    s_endpgm
L_SPIN19:
    ds_read_b32 v34, v32
    s_waitcnt lgkmcnt(0)
    v_cmp_gt_i32 vcc, v27, v34
    s_cbranch_vccz L_SRET20
    s_sleep 1
    s_add_u32 s84, s84, 1
    s_cmp_lt_u32 s84, 2097152
    s_cbranch_scc1 L_SPIN19
    s_endpgm
L_SPIN21:
    ds_read_b32 v34, v32
    s_waitcnt lgkmcnt(0)
    v_cmp_gt_i32 vcc, v27, v34
    s_cbranch_vccz L_SRET22
    s_sleep 1
    s_add_u32 s84, s84, 1
    s_cmp_lt_u32 s84, 2097152
    s_cbranch_scc1 L_SPIN21
    s_endpgm
L_SPIN23:
    ds_read_b32 v34, v32
    s_waitcnt lgkmcnt(0)
    v_cmp_gt_i32 vcc, v27, v34
    s_cbranch_vccz L_SRET24
    s_sleep 1
    s_add_u32 s84, s84, 1
    s_cmp_lt_u32 s84, 2097152
    s_cbranch_scc1 L_SPIN23
    s_endpgm
L_RARE11F:
    ds_read_b32 v34, v32
    s_waitcnt lgkmcnt(0)
    v_cmp_gt_i32 vcc, v27, v34
    s_cbranch_vccz L_RRET12
    s_sleep 1
    s_add_u32 s84, s84, 1
    s_cmp_lt_u32 s84, 2097152
    s_cbranch_scc1 L_RARE11F
    s_endpgm
L_RARE13F:
    ds_read_b32 v34, v32
    s_waitcnt lgkmcnt(0)
    v_cmp_gt_i32 vcc, v27, v34
    s_cbranch_vccz L_RRET14
    s_sleep 1
    s_add_u32 s84, s84, 1
    s_cmp_lt_u32 s84, 2097152
    s_cbranch_scc1 L_RARE13F
    s_endpgm
L_RARE15F:
    ds_read_b32 v34, v32
    s_waitcnt lgkmcnt(0)
    v_cmp_gt_i32 vcc, v27, v34
    s_cbranch_vccz L_RRET16
    s_sleep 1
    s_add_u32 s84, s84, 1
    s_cmp_lt_u32 s84, 2097152
    s_cbranch_scc1 L_RARE15F
    s_endpgm
L_LOADER:
    v_and_b32 v29, 1, v4
    v_lshl_add_u32 v7, v29, 2, v3
    s_movk_i32 s5, 1152
    v_mul_lo_u32 v7, v7, s5
    v_lshl_add_u32 v7, v5, 6, v7
    v_xor_b32 v30, v2, v29
    v_lshl_add_u32 v12, v30, 4, v7
    v_xor_b32 v13, 32, v12
    v_add_u32 v14, 16384, v12
    v_add_u32 v15, 24576, v13
    v_add_u32 v13, 8192, v13
    v_lshl_add_u32 v7, v4, 2, v2
    v_lshlrev_b32 v7, 4, v7
    v_lshl_add_u32 v16, v3, 13, v7
    v_add_u32 v17, 31744, v16
    v_add_u32 v18, 63488, v16
    v_add_u32 v19, 95232, v16
    s_mul_i32 s85, s8, 258048
    s_lshl_b32 s86, s9, 8
    v_mov_b32 v23, 0
    v_min_u32 v7, 6, v0
    v_lshlrev_b32 v7, 8, v7
    v_add_u32 v20, 90368, v7
    s_lshl_b32 s87, s11, 7
    s_add_u32 s87, s87, s85
    s_lshl_b32 s88, s11, 19
    s_add_u32 s88, s88, s86
    s_mov_b32 m0, 16384
    s_add_u32 s13, s88, 0
    buffer_load_dwordx4 v16, s[36:39], s13 offen offset:0 lds
    buffer_load_dwordx4 v17, s[36:39], s13 offen offset:1024 lds
    buffer_load_dwordx4 v18, s[36:39], s13 offen offset:2048 lds
    buffer_load_dwordx4 v19, s[36:39], s13 offen offset:3072 lds
    s_mov_b32 m0, 20480
    s_add_u32 s13, s88, 131072
    buffer_load_dwordx4 v16, s[36:39], s13 offen offset:0 lds
    buffer_load_dwordx4 v17, s[36:39], s13 offen offset:1024 lds
    buffer_load_dwordx4 v18, s[36:39], s13 offen offset:2048 lds
    buffer_load_dwordx4 v19, s[36:39], s13 offen offset:3072 lds
    s_mov_b32 m0, 126976
    s_add_u32 s13, s87, 0
    buffer_load_dwordx4 v12, s[32:35], s13 offen offset:0 lds
    buffer_load_dwordx4 v13, s[32:35], s13 offen offset:1024 lds
    buffer_load_dwordx4 v14, s[32:35], s13 offen offset:2048 lds
    buffer_load_dwordx4 v15, s[32:35], s13 offen offset:3072 lds
    s_mov_b32 m0, 131072
    s_add_u32 s13, s87, 36864
    buffer_load_dwordx4 v12, s[32:35], s13 offen offset:0 lds
    buffer_load_dwordx4 v13, s[32:35], s13 offen offset:1024 lds
    buffer_load_dwordx4 v14, s[32:35], s13 offen offset:2048 lds
    buffer_load_dwordx4 v15, s[32:35], s13 offen offset:3072 lds
    s_mov_b32 m0, 135168
    s_add_u32 s13, s87, 73728
    buffer_load_dwordx4 v12, s[32:35], s13 offen offset:0 lds
    buffer_load_dwordx4 v13, s[32:35], s13 offen offset:1024 lds
    buffer_load_dwordx4 v14, s[32:35], s13 offen offset:2048 lds
    buffer_load_dwordx4 v15, s[32:35], s13 offen offset:3072 lds
    s_mov_b32 m0, 139264
    s_add_u32 s13, s87, 110592
    buffer_load_dwordx4 v12, s[32:35], s13 offen offset:0 lds
    buffer_load_dwordx4 v13, s[32:35], s13 offen offset:1024 lds
    buffer_load_dwordx4 v14, s[32:35], s13 offen offset:2048 lds
    buffer_load_dwordx4 v15, s[32:35], s13 offen offset:3072 lds
    s_mov_b32 m0, 143360
    s_add_u32 s13, s87, 147456
    buffer_load_dwordx4 v12, s[32:35], s13 offen offset:0 lds
    buffer_load_dwordx4 v13, s[32:35], s13 offen offset:1024 lds
    buffer_load_dwordx4 v14, s[32:35], s13 offen offset:2048 lds
    buffer_load_dwordx4 v15, s[32:35], s13 offen offset:3072 lds
    s_mov_b32 m0, 147456
    s_add_u32 s13, s87, 184320
    buffer_load_dwordx4 v12, s[32:35], s13 offen offset:0 lds
    buffer_load_dwordx4 v13, s[32:35], s13 offen offset:1024 lds
    buffer_load_dwordx4 v14, s[32:35], s13 offen offset:2048 lds
    buffer_load_dwordx4 v15, s[32:35], s13 offen offset:3072 lds
    s_mov_b32 m0, 151552
    s_add_u32 s13, s87, 221184
    buffer_load_dwordx4 v12, s[32:35], s13 offen offset:0 lds
    buffer_load_dwordx4 v13, s[32:35], s13 offen offset:1024 lds
    buffer_load_dwordx4 v14, s[32:35], s13 offen offset:2048 lds
    buffer_load_dwordx4 v15, s[32:35], s13 offen offset:3072 lds
    s_mov_b32 m0, 24576
    s_add_u32 s13, s88, 262144
    buffer_load_dwordx4 v16, s[36:39], s13 offen offset:0 lds
    buffer_load_dwordx4 v17, s[36:39], s13 offen offset:1024 lds
    buffer_load_dwordx4 v18, s[36:39], s13 offen offset:2048 lds
    buffer_load_dwordx4 v19, s[36:39], s13 offen offset:3072 lds
    s_mov_b32 m0, 28672
    s_add_u32 s13, s88, 393216
    buffer_load_dwordx4 v16, s[36:39], s13 offen offset:0 lds
    buffer_load_dwordx4 v17, s[36:39], s13 offen offset:1024 lds
    buffer_load_dwordx4 v18, s[36:39], s13 offen offset:2048 lds
    buffer_load_dwordx4 v19, s[36:39], s13 offen offset:3072 lds
    s_add_u32 s11, s11, 1
    s_cmp_eq_u32 s11, 9
    s_cselect_b32 s11, 0, s11
    s_barrier
    s_mov_b32 m0, 90112
    s_add_u32 s13, s15, 4
    buffer_load_dword v23, s[48:51], s13 offen lds
    s_lshl_b32 s87, s11, 7
    s_add_u32 s87, s87, s85
    s_lshl_b32 s88, s11, 19
    s_add_u32 s88, s88, s86
    s_mov_b32 m0, 110592
    s_add_u32 s13, s88, 0
    buffer_load_dwordx4 v16, s[36:39], s13 offen offset:0 lds
    buffer_load_dwordx4 v17, s[36:39], s13 offen offset:1024 lds
    buffer_load_dwordx4 v18, s[36:39], s13 offen offset:2048 lds
    buffer_load_dwordx4 v19, s[36:39], s13 offen offset:3072 lds
    s_mov_b32 m0, 114688
    s_add_u32 s13, s88, 131072
    buffer_load_dwordx4 v16, s[36:39], s13 offen offset:0 lds
    buffer_load_dwordx4 v17, s[36:39], s13 offen offset:1024 lds
    buffer_load_dwordx4 v18, s[36:39], s13 offen offset:2048 lds
    buffer_load_dwordx4 v19, s[36:39], s13 offen offset:3072 lds
    s_mov_b32 m0, 32768
    s_add_u32 s13, s87, 0
    buffer_load_dwordx4 v12, s[32:35], s13 offen offset:0 lds
    buffer_load_dwordx4 v13, s[32:35], s13 offen offset:1024 lds
    buffer_load_dwordx4 v14, s[32:35], s13 offen offset:2048 lds
    buffer_load_dwordx4 v15, s[32:35], s13 offen offset:3072 lds
    s_mov_b32 m0, 36864
    s_add_u32 s13, s87, 36864
    buffer_load_dwordx4 v12, s[32:35], s13 offen offset:0 lds
    buffer_load_dwordx4 v13, s[32:35], s13 offen offset:1024 lds
    buffer_load_dwordx4 v14, s[32:35], s13 offen offset:2048 lds
    buffer_load_dwordx4 v15, s[32:35], s13 offen offset:3072 lds
    s_mov_b32 m0, 40960
    s_add_u32 s13, s87, 73728
    buffer_load_dwordx4 v12, s[32:35], s13 offen offset:0 lds
    buffer_load_dwordx4 v13, s[32:35], s13 offen offset:1024 lds
    buffer_load_dwordx4 v14, s[32:35], s13 offen offset:2048 lds
    buffer_load_dwordx4 v15, s[32:35], s13 offen offset:3072 lds
    s_mov_b32 m0, 45056
    s_add_u32 s13, s87, 110592
    buffer_load_dwordx4 v12, s[32:35], s13 offen offset:0 lds
    buffer_load_dwordx4 v13, s[32:35], s13 offen offset:1024 lds
    buffer_load_dwordx4 v14, s[32:35], s13 offen offset:2048 lds
    buffer_load_dwordx4 v15, s[32:35], s13 offen offset:3072 lds
    s_mov_b32 m0, 49152
    s_add_u32 s13, s87, 147456
    buffer_load_dwordx4 v12, s[32:35], s13 offen offset:0 lds
    buffer_load_dwordx4 v13, s[32:35], s13 offen offset:1024 lds
    buffer_load_dwordx4 v14, s[32:35], s13 offen offset:2048 lds
    buffer_load_dwordx4 v15, s[32:35], s13 offen offset:3072 lds
    s_mov_b32 m0, 53248
    s_add_u32 s13, s87, 184320
    buffer_load_dwordx4 v12, s[32:35], s13 offen offset:0 lds
    buffer_load_dwordx4 v13, s[32:35], s13 offen offset:1024 lds
    buffer_load_dwordx4 v14, s[32:35], s13 offen offset:2048 lds
    buffer_load_dwordx4 v15, s[32:35], s13 offen offset:3072 lds
    s_mov_b32 m0, 57344
    s_add_u32 s13, s87, 221184
    buffer_load_dwordx4 v12, s[32:35], s13 offen offset:0 lds
    buffer_load_dwordx4 v13, s[32:35], s13 offen offset:1024 lds
    buffer_load_dwordx4 v14, s[32:35], s13 offen offset:2048 lds
    buffer_load_dwordx4 v15, s[32:35], s13 offen offset:3072 lds
    s_mov_b32 m0, 118784
    s_add_u32 s13, s88, 262144
    buffer_load_dwordx4 v16, s[36:39], s13 offen offset:0 lds
    buffer_load_dwordx4 v17, s[36:39], s13 offen offset:1024 lds
    buffer_load_dwordx4 v18, s[36:39], s13 offen offset:2048 lds
    buffer_load_dwordx4 v19, s[36:39], s13 offen offset:3072 lds
    s_mov_b32 m0, 122880
    s_add_u32 s13, s88, 393216
    buffer_load_dwordx4 v16, s[36:39], s13 offen offset:0 lds
    buffer_load_dwordx4 v17, s[36:39], s13 offen offset:1024 lds
    buffer_load_dwordx4 v18, s[36:39], s13 offen offset:2048 lds
    buffer_load_dwordx4 v19, s[36:39], s13 offen offset:3072 lds
    s_add_u32 s11, s11, 1
    s_cmp_eq_u32 s11, 9
    s_cselect_b32 s11, 0, s11
    s_mov_b32 m0, 90112
    s_add_u32 s13, s15, 8
    buffer_load_dword v23, s[48:51], s13 offen lds
    s_lshl_b32 s87, s11, 7
    s_add_u32 s87, s87, s85
    s_lshl_b32 s88, s11, 19
    s_add_u32 s88, s88, s86
    s_mov_b32 m0, 94208
    s_add_u32 s13, s88, 0
    buffer_load_dwordx4 v16, s[36:39], s13 offen offset:0 lds
    buffer_load_dwordx4 v17, s[36:39], s13 offen offset:1024 lds
    buffer_load_dwordx4 v18, s[36:39], s13 offen offset:2048 lds
    buffer_load_dwordx4 v19, s[36:39], s13 offen offset:3072 lds
    s_mov_b32 m0, 98304
    s_add_u32 s13, s88, 131072
    buffer_load_dwordx4 v16, s[36:39], s13 offen offset:0 lds
    buffer_load_dwordx4 v17, s[36:39], s13 offen offset:1024 lds
    buffer_load_dwordx4 v18, s[36:39], s13 offen offset:2048 lds
    buffer_load_dwordx4 v19, s[36:39], s13 offen offset:3072 lds
    s_mov_b32 m0, 61440
    s_add_u32 s13, s87, 0
    buffer_load_dwordx4 v12, s[32:35], s13 offen offset:0 lds
    buffer_load_dwordx4 v13, s[32:35], s13 offen offset:1024 lds
    buffer_load_dwordx4 v14, s[32:35], s13 offen offset:2048 lds
    buffer_load_dwordx4 v15, s[32:35], s13 offen offset:3072 lds
    s_mov_b32 m0, 65536
    s_add_u32 s13, s87, 36864
    buffer_load_dwordx4 v12, s[32:35], s13 offen offset:0 lds
    buffer_load_dwordx4 v13, s[32:35], s13 offen offset:1024 lds
    buffer_load_dwordx4 v14, s[32:35], s13 offen offset:2048 lds
    buffer_load_dwordx4 v15, s[32:35], s13 offen offset:3072 lds
    s_mov_b32 m0, 69632
    s_add_u32 s13, s87, 73728
    buffer_load_dwordx4 v12, s[32:35], s13 offen offset:0 lds
    buffer_load_dwordx4 v13, s[32:35], s13 offen offset:1024 lds
    buffer_load_dwordx4 v14, s[32:35], s13 offen offset:2048 lds
    buffer_load_dwordx4 v15, s[32:35], s13 offen offset:3072 lds
    s_mov_b32 m0, 73728
    s_add_u32 s13, s87, 110592
    buffer_load_dwordx4 v12, s[32:35], s13 offen offset:0 lds
    buffer_load_dwordx4 v13, s[32:35], s13 offen offset:1024 lds
    buffer_load_dwordx4 v14, s[32:35], s13 offen offset:2048 lds
    buffer_load_dwordx4 v15, s[32:35], s13 offen offset:3072 lds
    s_mov_b32 m0, 77824
    s_add_u32 s13, s87, 147456
    buffer_load_dwordx4 v12, s[32:35], s13 offen offset:0 lds
    buffer_load_dwordx4 v13, s[32:35], s13 offen offset:1024 lds
    buffer_load_dwordx4 v14, s[32:35], s13 offen offset:2048 lds
    buffer_load_dwordx4 v15, s[32:35], s13 offen offset:3072 lds
    s_mov_b32 m0, 81920
    s_add_u32 s13, s87, 184320
    buffer_load_dwordx4 v12, s[32:35], s13 offen offset:0 lds
    buffer_load_dwordx4 v13, s[32:35], s13 offen offset:1024 lds
    buffer_load_dwordx4 v14, s[32:35], s13 offen offset:2048 lds
    buffer_load_dwordx4 v15, s[32:35], s13 offen offset:3072 lds
    s_mov_b32 m0, 86016
    s_add_u32 s13, s87, 221184
    buffer_load_dwordx4 v12, s[32:35], s13 offen offset:0 lds
    buffer_load_dwordx4 v13, s[32:35], s13 offen offset:1024 lds
    buffer_load_dwordx4 v14, s[32:35], s13 offen offset:2048 lds
    buffer_load_dwordx4 v15, s[32:35], s13 offen offset:3072 lds
    s_mov_b32 m0, 102400
    s_add_u32 s13, s88, 262144
    buffer_load_dwordx4 v16, s[36:39], s13 offen offset:0 lds
    buffer_load_dwordx4 v17, s[36:39], s13 offen offset:1024 lds
    buffer_load_dwordx4 v18, s[36:39], s13 offen offset:2048 lds
    buffer_load_dwordx4 v19, s[36:39], s13 offen offset:3072 lds
    s_mov_b32 m0, 106496
    s_add_u32 s13, s88, 393216
    buffer_load_dwordx4 v16, s[36:39], s13 offen offset:0 lds
    buffer_load_dwordx4 v17, s[36:39], s13 offen offset:1024 lds
    buffer_load_dwordx4 v18, s[36:39], s13 offen offset:2048 lds
    buffer_load_dwordx4 v19, s[36:39], s13 offen offset:3072 lds
    s_add_u32 s11, s11, 1
    s_cmp_eq_u32 s11, 9
    s_cselect_b32 s11, 0, s11
    s_mov_b32 m0, 90112
    s_add_u32 s13, s15, 12
    buffer_load_dword v23, s[48:51], s13 offen lds
    s_mov_b32 s10, 3
L_LQ:
    s_barrier
    s_lshl_b32 s87, s11, 7
    s_add_u32 s87, s87, s85
    s_lshl_b32 s88, s11, 19
    s_add_u32 s88, s88, s86
    s_mov_b32 m0, 16384
    s_add_u32 s13, s88, 0
    buffer_load_dwordx4 v16, s[36:39], s13 offen offset:0 lds
    buffer_load_dwordx4 v17, s[36:39], s13 offen offset:1024 lds
    buffer_load_dwordx4 v18, s[36:39], s13 offen offset:2048 lds
    buffer_load_dwordx4 v19, s[36:39], s13 offen offset:3072 lds
    s_mov_b32 m0, 20480
    s_add_u32 s13, s88, 131072
    buffer_load_dwordx4 v16, s[36:39], s13 offen offset:0 lds
    buffer_load_dwordx4 v17, s[36:39], s13 offen offset:1024 lds
    buffer_load_dwordx4 v18, s[36:39], s13 offen offset:2048 lds
    buffer_load_dwordx4 v19, s[36:39], s13 offen offset:3072 lds
    s_mov_b32 m0, 126976
    s_add_u32 s13, s87, 0
    buffer_load_dwordx4 v12, s[32:35], s13 offen offset:0 lds
    buffer_load_dwordx4 v13, s[32:35], s13 offen offset:1024 lds
    buffer_load_dwordx4 v14, s[32:35], s13 offen offset:2048 lds
    buffer_load_dwordx4 v15, s[32:35], s13 offen offset:3072 lds
    s_mov_b32 m0, 131072
    s_add_u32 s13, s87, 36864
    buffer_load_dwordx4 v12, s[32:35], s13 offen offset:0 lds
    buffer_load_dwordx4 v13, s[32:35], s13 offen offset:1024 lds
    buffer_load_dwordx4 v14, s[32:35], s13 offen offset:2048 lds
    buffer_load_dwordx4 v15, s[32:35], s13 offen offset:3072 lds
    s_mov_b32 m0, 135168
    s_add_u32 s13, s87, 73728
    buffer_load_dwordx4 v12, s[32:35], s13 offen offset:0 lds
    buffer_load_dwordx4 v13, s[32:35], s13 offen offset:1024 lds
    buffer_load_dwordx4 v14, s[32:35], s13 offen offset:2048 lds
    buffer_load_dwordx4 v15, s[32:35], s13 offen offset:3072 lds
    s_mov_b32 m0, 139264
    s_add_u32 s13, s87, 110592
    buffer_load_dwordx4 v12, s[32:35], s13 offen offset:0 lds
    buffer_load_dwordx4 v13, s[32:35], s13 offen offset:1024 lds
    buffer_load_dwordx4 v14, s[32:35], s13 offen offset:2048 lds
    buffer_load_dwordx4 v15, s[32:35], s13 offen offset:3072 lds
    s_mov_b32 m0, 143360
    s_add_u32 s13, s87, 147456
    buffer_load_dwordx4 v12, s[32:35], s13 offen offset:0 lds
    buffer_load_dwordx4 v13, s[32:35], s13 offen offset:1024 lds
    buffer_load_dwordx4 v14, s[32:35], s13 offen offset:2048 lds
    buffer_load_dwordx4 v15, s[32:35], s13 offen offset:3072 lds
    s_mov_b32 m0, 147456
    s_add_u32 s13, s87, 184320
    buffer_load_dwordx4 v12, s[32:35], s13 offen offset:0 lds
    buffer_load_dwordx4 v13, s[32:35], s13 offen offset:1024 lds
    buffer_load_dwordx4 v14, s[32:35], s13 offen offset:2048 lds
    buffer_load_dwordx4 v15, s[32:35], s13 offen offset:3072 lds
    s_mov_b32 m0, 151552
    s_add_u32 s13, s87, 221184
    buffer_load_dwordx4 v12, s[32:35], s13 offen offset:0 lds
    buffer_load_dwordx4 v13, s[32:35], s13 offen offset:1024 lds
    buffer_load_dwordx4 v14, s[32:35], s13 offen offset:2048 lds
    buffer_load_dwordx4 v15, s[32:35], s13 offen offset:3072 lds
    s_mov_b32 m0, 24576
    s_add_u32 s13, s88, 262144
    buffer_load_dwordx4 v16, s[36:39], s13 offen offset:0 lds
    buffer_load_dwordx4 v17, s[36:39], s13 offen offset:1024 lds
    buffer_load_dwordx4 v18, s[36:39], s13 offen offset:2048 lds
    buffer_load_dwordx4 v19, s[36:39], s13 offen offset:3072 lds
    s_mov_b32 m0, 28672
    s_add_u32 s13, s88, 393216
    buffer_load_dwordx4 v16, s[36:39], s13 offen offset:0 lds
    buffer_load_dwordx4 v17, s[36:39], s13 offen offset:1024 lds
    buffer_load_dwordx4 v18, s[36:39], s13 offen offset:2048 lds
    buffer_load_dwordx4 v19, s[36:39], s13 offen offset:3072 lds
    s_add_u32 s11, s11, 1
    s_cmp_eq_u32 s11, 9
    s_cselect_b32 s11, 0, s11
    s_add_u32 s10, s10, 1
    s_mov_b32 m0, 90112
    s_lshl_b32 s13, s10, 2
    s_add_u32 s13, s13, s15
    buffer_load_dword v23, s[48:51], s13 offen lds
    s_barrier
    s_lshl_b32 s87, s11, 7
    s_add_u32 s87, s87, s85
    s_lshl_b32 s88, s11, 19
    s_add_u32 s88, s88, s86
    s_mov_b32 m0, 110592
    s_add_u32 s13, s88, 0
    buffer_load_dwordx4 v16, s[36:39], s13 offen offset:0 lds
    buffer_load_dwordx4 v17, s[36:39], s13 offen offset:1024 lds
    buffer_load_dwordx4 v18, s[36:39], s13 offen offset:2048 lds
    buffer_load_dwordx4 v19, s[36:39], s13 offen offset:3072 lds
    s_mov_b32 m0, 114688
    s_add_u32 s13, s88, 131072
    buffer_load_dwordx4 v16, s[36:39], s13 offen offset:0 lds
    buffer_load_dwordx4 v17, s[36:39], s13 offen offset:1024 lds
    buffer_load_dwordx4 v18, s[36:39], s13 offen offset:2048 lds
    buffer_load_dwordx4 v19, s[36:39], s13 offen offset:3072 lds
    s_mov_b32 m0, 32768
    s_add_u32 s13, s87, 0
    buffer_load_dwordx4 v12, s[32:35], s13 offen offset:0 lds
    buffer_load_dwordx4 v13, s[32:35], s13 offen offset:1024 lds
    buffer_load_dwordx4 v14, s[32:35], s13 offen offset:2048 lds
    buffer_load_dwordx4 v15, s[32:35], s13 offen offset:3072 lds
    s_mov_b32 m0, 36864
    s_add_u32 s13, s87, 36864
    buffer_load_dwordx4 v12, s[32:35], s13 offen offset:0 lds
    buffer_load_dwordx4 v13, s[32:35], s13 offen offset:1024 lds
    buffer_load_dwordx4 v14, s[32:35], s13 offen offset:2048 lds
    buffer_load_dwordx4 v15, s[32:35], s13 offen offset:3072 lds
    s_mov_b32 m0, 40960
    s_add_u32 s13, s87, 73728
    buffer_load_dwordx4 v12, s[32:35], s13 offen offset:0 lds
    buffer_load_dwordx4 v13, s[32:35], s13 offen offset:1024 lds
    buffer_load_dwordx4 v14, s[32:35], s13 offen offset:2048 lds
    buffer_load_dwordx4 v15, s[32:35], s13 offen offset:3072 lds
    s_mov_b32 m0, 45056
    s_add_u32 s13, s87, 110592
    buffer_load_dwordx4 v12, s[32:35], s13 offen offset:0 lds
    buffer_load_dwordx4 v13, s[32:35], s13 offen offset:1024 lds
    buffer_load_dwordx4 v14, s[32:35], s13 offen offset:2048 lds
    buffer_load_dwordx4 v15, s[32:35], s13 offen offset:3072 lds
    s_mov_b32 m0, 49152
    s_add_u32 s13, s87, 147456
    buffer_load_dwordx4 v12, s[32:35], s13 offen offset:0 lds
    buffer_load_dwordx4 v13, s[32:35], s13 offen offset:1024 lds
    buffer_load_dwordx4 v14, s[32:35], s13 offen offset:2048 lds
    buffer_load_dwordx4 v15, s[32:35], s13 offen offset:3072 lds
    s_mov_b32 m0, 53248
    s_add_u32 s13, s87, 184320
    buffer_load_dwordx4 v12, s[32:35], s13 offen offset:0 lds
    buffer_load_dwordx4 v13, s[32:35], s13 offen offset:1024 lds
    buffer_load_dwordx4 v14, s[32:35], s13 offen offset:2048 lds
    buffer_load_dwordx4 v15, s[32:35], s13 offen offset:3072 lds
    s_mov_b32 m0, 57344
    s_add_u32 s13, s87, 221184
    buffer_load_dwordx4 v12, s[32:35], s13 offen offset:0 lds
    buffer_load_dwordx4 v13, s[32:35], s13 offen offset:1024 lds
    buffer_load_dwordx4 v14, s[32:35], s13 offen offset:2048 lds
    buffer_load_dwordx4 v15, s[32:35], s13 offen offset:3072 lds
    s_mov_b32 m0, 118784
    s_add_u32 s13, s88, 262144
    buffer_load_dwordx4 v16, s[36:39], s13 offen offset:0 lds
    buffer_load_dwordx4 v17, s[36:39], s13 offen offset:1024 lds
    buffer_load_dwordx4 v18, s[36:39], s13 offen offset:2048 lds
    buffer_load_dwordx4 v19, s[36:39], s13 offen offset:3072 lds
    s_mov_b32 m0, 122880
    s_add_u32 s13, s88, 393216
    buffer_load_dwordx4 v16, s[36:39], s13 offen offset:0 lds
    buffer_load_dwordx4 v17, s[36:39], s13 offen offset:1024 lds
    buffer_load_dwordx4 v18, s[36:39], s13 offen offset:2048 lds
    buffer_load_dwordx4 v19, s[36:39], s13 offen offset:3072 lds
    s_add_u32 s11, s11, 1
    s_cmp_eq_u32 s11, 9
    s_cselect_b32 s11, 0, s11
    s_add_u32 s10, s10, 1
    s_mov_b32 m0, 90112
    s_lshl_b32 s13, s10, 2
    s_add_u32 s13, s13, s15
    buffer_load_dword v23, s[48:51], s13 offen lds
    s_barrier
    s_lshl_b32 s87, s11, 7
    s_add_u32 s87, s87, s85
    s_lshl_b32 s88, s11, 19
    s_add_u32 s88, s88, s86
    s_mov_b32 m0, 94208
    s_add_u32 s13, s88, 0
    buffer_load_dwordx4 v16, s[36:39], s13 offen offset:0 lds
    buffer_load_dwordx4 v17, s[36:39], s13 offen offset:1024 lds
    buffer_load_dwordx4 v18, s[36:39], s13 offen offset:2048 lds
    buffer_load_dwordx4 v19, s[36:39], s13 offen offset:3072 lds
    s_mov_b32 m0, 98304
    s_add_u32 s13, s88, 131072
    buffer_load_dwordx4 v16, s[36:39], s13 offen offset:0 lds
    buffer_load_dwordx4 v17, s[36:39], s13 offen offset:1024 lds
    buffer_load_dwordx4 v18, s[36:39], s13 offen offset:2048 lds
    buffer_load_dwordx4 v19, s[36:39], s13 offen offset:3072 lds
    s_mov_b32 m0, 61440
    s_add_u32 s13, s87, 0
    buffer_load_dwordx4 v12, s[32:35], s13 offen offset:0 lds
    buffer_load_dwordx4 v13, s[32:35], s13 offen offset:1024 lds
    buffer_load_dwordx4 v14, s[32:35], s13 offen offset:2048 lds
    buffer_load_dwordx4 v15, s[32:35], s13 offen offset:3072 lds
    s_mov_b32 m0, 65536
    s_add_u32 s13, s87, 36864
    buffer_load_dwordx4 v12, s[32:35], s13 offen offset:0 lds
    buffer_load_dwordx4 v13, s[32:35], s13 offen offset:1024 lds
    buffer_load_dwordx4 v14, s[32:35], s13 offen offset:2048 lds
    buffer_load_dwordx4 v15, s[32:35], s13 offen offset:3072 lds
    s_mov_b32 m0, 69632
    s_add_u32 s13, s87, 73728
    buffer_load_dwordx4 v12, s[32:35], s13 offen offset:0 lds
    buffer_load_dwordx4 v13, s[32:35], s13 offen offset:1024 lds
    buffer_load_dwordx4 v14, s[32:35], s13 offen offset:2048 lds
    buffer_load_dwordx4 v15, s[32:35], s13 offen offset:3072 lds
    s_mov_b32 m0, 73728
    s_add_u32 s13, s87, 110592
    buffer_load_dwordx4 v12, s[32:35], s13 offen offset:0 lds
    buffer_load_dwordx4 v13, s[32:35], s13 offen offset:1024 lds
    buffer_load_dwordx4 v14, s[32:35], s13 offen offset:2048 lds
    buffer_load_dwordx4 v15, s[32:35], s13 offen offset:3072 lds
    s_mov_b32 m0, 77824
    s_add_u32 s13, s87, 147456
    buffer_load_dwordx4 v12, s[32:35], s13 offen offset:0 lds
    buffer_load_dwordx4 v13, s[32:35], s13 offen offset:1024 lds
    buffer_load_dwordx4 v14, s[32:35], s13 offen offset:2048 lds
    buffer_load_dwordx4 v15, s[32:35], s13 offen offset:3072 lds
    s_mov_b32 m0, 81920
    s_add_u32 s13, s87, 184320
    buffer_load_dwordx4 v12, s[32:35], s13 offen offset:0 lds
    buffer_load_dwordx4 v13, s[32:35], s13 offen offset:1024 lds
    buffer_load_dwordx4 v14, s[32:35], s13 offen offset:2048 lds
    buffer_load_dwordx4 v15, s[32:35], s13 offen offset:3072 lds
    s_mov_b32 m0, 86016
    s_add_u32 s13, s87, 221184
    buffer_load_dwordx4 v12, s[32:35], s13 offen offset:0 lds
    buffer_load_dwordx4 v13, s[32:35], s13 offen offset:1024 lds
    buffer_load_dwordx4 v14, s[32:35], s13 offen offset:2048 lds
    buffer_load_dwordx4 v15, s[32:35], s13 offen offset:3072 lds
    s_mov_b32 m0, 102400
    s_add_u32 s13, s88, 262144
    buffer_load_dwordx4 v16, s[36:39], s13 offen offset:0 lds
    buffer_load_dwordx4 v17, s[36:39], s13 offen offset:1024 lds
    buffer_load_dwordx4 v18, s[36:39], s13 offen offset:2048 lds
    buffer_load_dwordx4 v19, s[36:39], s13 offen offset:3072 lds
    s_mov_b32 m0, 106496
    s_add_u32 s13, s88, 393216
    buffer_load_dwordx4 v16, s[36:39], s13 offen offset:0 lds
    buffer_load_dwordx4 v17, s[36:39], s13 offen offset:1024 lds
    buffer_load_dwordx4 v18, s[36:39], s13 offen offset:2048 lds
    buffer_load_dwordx4 v19, s[36:39], s13 offen offset:3072 lds
    s_add_u32 s11, s11, 1
    s_cmp_eq_u32 s11, 9
    s_cselect_b32 s11, 0, s11
    s_add_u32 s10, s10, 1
    s_mov_b32 m0, 90112
    s_lshl_b32 s13, s10, 2
    s_add_u32 s13, s13, s15
    buffer_load_dword v23, s[48:51], s13 offen lds
    s_cmp_lt_u32 s10, 9
    s_cbranch_scc1 L_LQ
    v_xor_b32 v7, 0, v2
    v_lshl_add_u32 v7, v4, 2, v7
    v_lshlrev_b32 v7, 4, v7
    v_lshl_add_u32 v8, v3, 8, v7
    v_xor_b32 v7, 1, v2
    v_lshl_add_u32 v7, v4, 2, v7
    v_lshlrev_b32 v7, 4, v7
    v_lshl_add_u32 v9, v3, 8, v7
    v_xor_b32 v7, 2, v2
    v_lshl_add_u32 v7, v4, 2, v7
    v_lshlrev_b32 v7, 4, v7
    v_lshl_add_u32 v10, v3, 8, v7
    v_xor_b32 v7, 3, v2
    v_lshl_add_u32 v7, v4, 2, v7
    v_lshlrev_b32 v7, 4, v7
    v_lshl_add_u32 v11, v3, 8, v7
    s_lshl_b32 s4, s8, 5
    s_add_u32 s4, s4, s9
    s_lshl_b32 s12, s4, 17
    buffer_load_dword v38, v23, s[60:63], 0 offen sc1
    s_mov_b32 m0, 0
    s_add_u32 s13, s12, 0
    buffer_load_dwordx4 v8, s[40:43], s13 offen offset:0 nt lds
    buffer_load_dwordx4 v9, s[40:43], s13 offen offset:1024 nt lds
    buffer_load_dwordx4 v10, s[40:43], s13 offen offset:2048 nt lds
    buffer_load_dwordx4 v11, s[40:43], s13 offen offset:3072 nt lds
    s_mov_b32 m0, 4096
    s_add_u32 s13, s12, 4096
    buffer_load_dwordx4 v8, s[40:43], s13 offen offset:0 nt lds
    buffer_load_dwordx4 v9, s[40:43], s13 offen offset:1024 nt lds
    buffer_load_dwordx4 v10, s[40:43], s13 offen offset:2048 nt lds
    buffer_load_dwordx4 v11, s[40:43], s13 offen offset:3072 nt lds
    s_mov_b32 m0, 8192
    s_add_u32 s13, s12, 8192
    buffer_load_dwordx4 v8, s[40:43], s13 offen offset:0 nt lds
    buffer_load_dwordx4 v9, s[40:43], s13 offen offset:1024 nt lds
    buffer_load_dwordx4 v10, s[40:43], s13 offen offset:2048 nt lds
    buffer_load_dwordx4 v11, s[40:43], s13 offen offset:3072 nt lds
    s_mov_b32 m0, 12288
    s_add_u32 s13, s12, 12288
    buffer_load_dwordx4 v8, s[40:43], s13 offen offset:0 nt lds
    buffer_load_dwordx4 v9, s[40:43], s13 offen offset:1024 nt lds
    buffer_load_dwordx4 v10, s[40:43], s13 offen offset:2048 nt lds
    buffer_load_dwordx4 v11, s[40:43], s13 offen offset:3072 nt lds
    s_mov_b32 m0, 90112
    s_add_u32 s13, s15, 40
    buffer_load_dword v23, s[48:51], s13 offen lds
    s_mov_b32 m0, 155648
    s_add_u32 s13, s12, 0
    buffer_load_dwordx4 v8, s[44:47], s13 offen offset:0 nt lds
    buffer_load_dwordx4 v8, s[44:47], s13 offen offset:1024 nt lds
    buffer_load_dwordx4 v8, s[44:47], s13 offen offset:2048 nt lds
    buffer_load_dwordx4 v8, s[44:47], s13 offen offset:3072 nt lds
    s_mov_b32 m0, 159744
    s_add_u32 s13, s12, 4096
    buffer_load_dwordx4 v8, s[44:47], s13 offen offset:0 nt lds
    buffer_load_dwordx4 v8, s[44:47], s13 offen offset:1024 nt lds
    buffer_load_dwordx4 v8, s[44:47], s13 offen offset:2048 nt lds
    buffer_load_dwordx4 v8, s[44:47], s13 offen offset:3072 nt lds
L_LW25:
    ds_read_b32 v21, v20
    s_waitcnt lgkmcnt(0)
    v_cmp_gt_u32 vcc, 7, v21
    s_cbranch_vccz L_LX26
    s_sleep 1
    s_add_u32 s84, s84, 1
    s_cmp_lt_u32 s84, 2097152
    s_cbranch_scc1 L_LW25
    s_endpgm
L_LX26:
    s_mov_b32 m0, 16384
    s_add_u32 s13, s12, 16384
    buffer_load_dwordx4 v8, s[40:43], s13 offen offset:0 nt lds
    buffer_load_dwordx4 v9, s[40:43], s13 offen offset:1024 nt lds
    buffer_load_dwordx4 v10, s[40:43], s13 offen offset:2048 nt lds
    buffer_load_dwordx4 v11, s[40:43], s13 offen offset:3072 nt lds
    s_mov_b32 m0, 20480
    s_add_u32 s13, s12, 20480
    buffer_load_dwordx4 v8, s[40:43], s13 offen offset:0 nt lds
    buffer_load_dwordx4 v9, s[40:43], s13 offen offset:1024 nt lds
    buffer_load_dwordx4 v10, s[40:43], s13 offen offset:2048 nt lds
    buffer_load_dwordx4 v11, s[40:43], s13 offen offset:3072 nt lds
    s_mov_b32 m0, 90112
    s_add_u32 s13, s15, 44
    buffer_load_dword v23, s[48:51], s13 offen lds
    s_mov_b32 m0, 147456
    s_add_u32 s13, s12, 8192
    buffer_load_dwordx4 v8, s[44:47], s13 offen offset:0 nt lds
    buffer_load_dwordx4 v8, s[44:47], s13 offen offset:1024 nt lds
    buffer_load_dwordx4 v8, s[44:47], s13 offen offset:2048 nt lds
    buffer_load_dwordx4 v8, s[44:47], s13 offen offset:3072 nt lds
    s_mov_b32 m0, 151552
    s_add_u32 s13, s12, 12288
    buffer_load_dwordx4 v8, s[44:47], s13 offen offset:0 nt lds
    buffer_load_dwordx4 v8, s[44:47], s13 offen offset:1024 nt lds
    buffer_load_dwordx4 v8, s[44:47], s13 offen offset:2048 nt lds
    buffer_load_dwordx4 v8, s[44:47], s13 offen offset:3072 nt lds
    s_mov_b32 m0, 24576
    s_add_u32 s13, s12, 24576
    buffer_load_dwordx4 v8, s[40:43], s13 offen offset:0 nt lds
    buffer_load_dwordx4 v9, s[40:43], s13 offen offset:1024 nt lds
    buffer_load_dwordx4 v10, s[40:43], s13 offen offset:2048 nt lds
    buffer_load_dwordx4 v11, s[40:43], s13 offen offset:3072 nt lds
    s_mov_b32 m0, 28672
    s_add_u32 s13, s12, 28672
    buffer_load_dwordx4 v8, s[40:43], s13 offen offset:0 nt lds
    buffer_load_dwordx4 v9, s[40:43], s13 offen offset:1024 nt lds
    buffer_load_dwordx4 v10, s[40:43], s13 offen offset:2048 nt lds
    buffer_load_dwordx4 v11, s[40:43], s13 offen offset:3072 nt lds
    s_mov_b32 m0, 90112
    s_add_u32 s13, s15, 48
    buffer_load_dword v23, s[48:51], s13 offen lds
    s_waitcnt vmcnt(40)
L_TK0:
    v_cmp_ne_u32 vcc, 0, v38
    s_cbranch_vccnz L_TK1
    buffer_load_dword v38, v23, s[60:63], 0 offen sc1
    s_waitcnt vmcnt(0)
    s_sleep 8
    s_add_u32 s84, s84, 1
    s_cmp_lt_u32 s84, 2097152
    s_cbranch_scc1 L_TK0
    s_endpgm
L_TK1:
    s_getreg_b32 s5, hwreg(HW_REG_XCC_ID, 0, 4)
    v_or_b32 v24, s5, v38
    s_lshl_b32 s4, s92, 7
    s_lshl_b32 s5, s94, 2
    s_add_u32 s4, s4, s5
    s_add_u32 s4, s4, 34734080
    buffer_store_dword v24, v23, s[48:51], s4 offen sc1
    s_mov_b32 m0, 139264
    s_add_u32 s13, s12, 16384
    buffer_load_dwordx4 v8, s[44:47], s13 offen offset:0 nt lds
    buffer_load_dwordx4 v8, s[44:47], s13 offen offset:1024 nt lds
    buffer_load_dwordx4 v8, s[44:47], s13 offen offset:2048 nt lds
    buffer_load_dwordx4 v8, s[44:47], s13 offen offset:3072 nt lds
    s_mov_b32 m0, 143360
    s_add_u32 s13, s12, 20480
    buffer_load_dwordx4 v8, s[44:47], s13 offen offset:0 nt lds
    buffer_load_dwordx4 v8, s[44:47], s13 offen offset:1024 nt lds
    buffer_load_dwordx4 v8, s[44:47], s13 offen offset:2048 nt lds
    buffer_load_dwordx4 v8, s[44:47], s13 offen offset:3072 nt lds
L_LW27:
    ds_read_b32 v21, v20
    s_waitcnt lgkmcnt(0)
    v_cmp_gt_u32 vcc, 8, v21
    s_cbranch_vccz L_LX28
    s_sleep 1
    s_add_u32 s84, s84, 1
    s_cmp_lt_u32 s84, 2097152
    s_cbranch_scc1 L_LW27
    s_endpgm
L_LX28:
    s_mov_b32 m0, 32768
    s_add_u32 s13, s12, 32768
    buffer_load_dwordx4 v8, s[40:43], s13 offen offset:0 nt lds
    buffer_load_dwordx4 v9, s[40:43], s13 offen offset:1024 nt lds
    buffer_load_dwordx4 v10, s[40:43], s13 offen offset:2048 nt lds
    buffer_load_dwordx4 v11, s[40:43], s13 offen offset:3072 nt lds
    s_mov_b32 m0, 36864
    s_add_u32 s13, s12, 36864
    buffer_load_dwordx4 v8, s[40:43], s13 offen offset:0 nt lds
    buffer_load_dwordx4 v9, s[40:43], s13 offen offset:1024 nt lds
    buffer_load_dwordx4 v10, s[40:43], s13 offen offset:2048 nt lds
    buffer_load_dwordx4 v11, s[40:43], s13 offen offset:3072 nt lds
    s_mov_b32 m0, 90112
    s_add_u32 s13, s15, 52
    buffer_load_dword v23, s[48:51], s13 offen lds
    s_mov_b32 m0, 131072
    s_add_u32 s13, s12, 24576
    buffer_load_dwordx4 v8, s[44:47], s13 offen offset:0 nt lds
    buffer_load_dwordx4 v8, s[44:47], s13 offen offset:1024 nt lds
    buffer_load_dwordx4 v8, s[44:47], s13 offen offset:2048 nt lds
    buffer_load_dwordx4 v8, s[44:47], s13 offen offset:3072 nt lds
    s_mov_b32 m0, 135168
    s_add_u32 s13, s12, 28672
    buffer_load_dwordx4 v8, s[44:47], s13 offen offset:0 nt lds
    buffer_load_dwordx4 v8, s[44:47], s13 offen offset:1024 nt lds
    buffer_load_dwordx4 v8, s[44:47], s13 offen offset:2048 nt lds
    buffer_load_dwordx4 v8, s[44:47], s13 offen offset:3072 nt lds
    s_mov_b32 m0, 40960
    s_add_u32 s13, s12, 40960
    buffer_load_dwordx4 v8, s[40:43], s13 offen offset:0 nt lds
    buffer_load_dwordx4 v9, s[40:43], s13 offen offset:1024 nt lds
    buffer_load_dwordx4 v10, s[40:43], s13 offen offset:2048 nt lds
    buffer_load_dwordx4 v11, s[40:43], s13 offen offset:3072 nt lds
    s_mov_b32 m0, 45056
    s_add_u32 s13, s12, 45056
    buffer_load_dwordx4 v8, s[40:43], s13 offen offset:0 nt lds
    buffer_load_dwordx4 v9, s[40:43], s13 offen offset:1024 nt lds
    buffer_load_dwordx4 v10, s[40:43], s13 offen offset:2048 nt lds
    buffer_load_dwordx4 v11, s[40:43], s13 offen offset:3072 nt lds
    s_mov_b32 m0, 90112
    s_add_u32 s13, s15, 56
    buffer_load_dword v23, s[48:51], s13 offen lds
    s_mov_b32 m0, 122880
    s_add_u32 s13, s12, 32768
    buffer_load_dwordx4 v8, s[44:47], s13 offen offset:0 nt lds
    buffer_load_dwordx4 v8, s[44:47], s13 offen offset:1024 nt lds
    buffer_load_dwordx4 v8, s[44:47], s13 offen offset:2048 nt lds
    buffer_load_dwordx4 v8, s[44:47], s13 offen offset:3072 nt lds
    s_mov_b32 m0, 126976
    s_add_u32 s13, s12, 36864
    buffer_load_dwordx4 v8, s[44:47], s13 offen offset:0 nt lds
    buffer_load_dwordx4 v8, s[44:47], s13 offen offset:1024 nt lds
    buffer_load_dwordx4 v8, s[44:47], s13 offen offset:2048 nt lds
    buffer_load_dwordx4 v8, s[44:47], s13 offen offset:3072 nt lds
    s_mov_b32 m0, 49152
    s_add_u32 s13, s12, 49152
    buffer_load_dwordx4 v8, s[40:43], s13 offen offset:0 nt lds
    buffer_load_dwordx4 v9, s[40:43], s13 offen offset:1024 nt lds
    buffer_load_dwordx4 v10, s[40:43], s13 offen offset:2048 nt lds
    buffer_load_dwordx4 v11, s[40:43], s13 offen offset:3072 nt lds
    s_mov_b32 m0, 53248
    s_add_u32 s13, s12, 53248
    buffer_load_dwordx4 v8, s[40:43], s13 offen offset:0 nt lds
    buffer_load_dwordx4 v9, s[40:43], s13 offen offset:1024 nt lds
    buffer_load_dwordx4 v10, s[40:43], s13 offen offset:2048 nt lds
    buffer_load_dwordx4 v11, s[40:43], s13 offen offset:3072 nt lds
    s_mov_b32 m0, 90112
    s_add_u32 s13, s15, 60
    buffer_load_dword v23, s[48:51], s13 offen lds
    s_mov_b32 m0, 114688
    s_add_u32 s13, s12, 40960
    buffer_load_dwordx4 v8, s[44:47], s13 offen offset:0 nt lds
    buffer_load_dwordx4 v8, s[44:47], s13 offen offset:1024 nt lds
    buffer_load_dwordx4 v8, s[44:47], s13 offen offset:2048 nt lds
    buffer_load_dwordx4 v8, s[44:47], s13 offen offset:3072 nt lds
    s_mov_b32 m0, 118784
    s_add_u32 s13, s12, 45056
    buffer_load_dwordx4 v8, s[44:47], s13 offen offset:0 nt lds
    buffer_load_dwordx4 v8, s[44:47], s13 offen offset:1024 nt lds
    buffer_load_dwordx4 v8, s[44:47], s13 offen offset:2048 nt lds
    buffer_load_dwordx4 v8, s[44:47], s13 offen offset:3072 nt lds
L_LW29:
    ds_read_b32 v21, v20
    s_waitcnt lgkmcnt(0)
    v_cmp_gt_u32 vcc, 10, v21
    s_cbranch_vccz L_LX30
    s_sleep 1
    s_add_u32 s84, s84, 1
    s_cmp_lt_u32 s84, 2097152
    s_cbranch_scc1 L_LW29
    s_endpgm
L_LX30:
    s_mov_b32 m0, 57344
    s_add_u32 s13, s12, 57344
    buffer_load_dwordx4 v8, s[40:43], s13 offen offset:0 nt lds
    buffer_load_dwordx4 v9, s[40:43], s13 offen offset:1024 nt lds
    buffer_load_dwordx4 v10, s[40:43], s13 offen offset:2048 nt lds
    buffer_load_dwordx4 v11, s[40:43], s13 offen offset:3072 nt lds
    s_mov_b32 m0, 61440
    s_add_u32 s13, s12, 61440
    buffer_load_dwordx4 v8, s[40:43], s13 offen offset:0 nt lds
    buffer_load_dwordx4 v9, s[40:43], s13 offen offset:1024 nt lds
    buffer_load_dwordx4 v10, s[40:43], s13 offen offset:2048 nt lds
    buffer_load_dwordx4 v11, s[40:43], s13 offen offset:3072 nt lds
    s_mov_b32 m0, 90112
    s_add_u32 s13, s15, 64
    buffer_load_dword v23, s[48:51], s13 offen lds
    s_mov_b32 m0, 106496
    s_add_u32 s13, s12, 49152
    buffer_load_dwordx4 v8, s[44:47], s13 offen offset:0 nt lds
    buffer_load_dwordx4 v8, s[44:47], s13 offen offset:1024 nt lds
    buffer_load_dwordx4 v8, s[44:47], s13 offen offset:2048 nt lds
    buffer_load_dwordx4 v8, s[44:47], s13 offen offset:3072 nt lds
    s_mov_b32 m0, 110592
    s_add_u32 s13, s12, 53248
    buffer_load_dwordx4 v8, s[44:47], s13 offen offset:0 nt lds
    buffer_load_dwordx4 v8, s[44:47], s13 offen offset:1024 nt lds
    buffer_load_dwordx4 v8, s[44:47], s13 offen offset:2048 nt lds
    buffer_load_dwordx4 v8, s[44:47], s13 offen offset:3072 nt lds
    s_mov_b32 m0, 65536
    s_add_u32 s13, s12, 65536
    buffer_load_dwordx4 v8, s[40:43], s13 offen offset:0 nt lds
    buffer_load_dwordx4 v9, s[40:43], s13 offen offset:1024 nt lds
    buffer_load_dwordx4 v10, s[40:43], s13 offen offset:2048 nt lds
    buffer_load_dwordx4 v11, s[40:43], s13 offen offset:3072 nt lds
    s_mov_b32 m0, 69632
    s_add_u32 s13, s12, 69632
    buffer_load_dwordx4 v8, s[40:43], s13 offen offset:0 nt lds
    buffer_load_dwordx4 v9, s[40:43], s13 offen offset:1024 nt lds
    buffer_load_dwordx4 v10, s[40:43], s13 offen offset:2048 nt lds
    buffer_load_dwordx4 v11, s[40:43], s13 offen offset:3072 nt lds
    s_mov_b32 m0, 90112
    s_add_u32 s13, s15, 68
    buffer_load_dword v23, s[48:51], s13 offen lds
    s_mov_b32 m0, 98304
    s_add_u32 s13, s12, 57344
    buffer_load_dwordx4 v8, s[44:47], s13 offen offset:0 nt lds
    buffer_load_dwordx4 v8, s[44:47], s13 offen offset:1024 nt lds
    buffer_load_dwordx4 v8, s[44:47], s13 offen offset:2048 nt lds
    buffer_load_dwordx4 v8, s[44:47], s13 offen offset:3072 nt lds
    s_mov_b32 m0, 102400
    s_add_u32 s13, s12, 61440
    buffer_load_dwordx4 v8, s[44:47], s13 offen offset:0 nt lds
    buffer_load_dwordx4 v8, s[44:47], s13 offen offset:1024 nt lds
    buffer_load_dwordx4 v8, s[44:47], s13 offen offset:2048 nt lds
    buffer_load_dwordx4 v8, s[44:47], s13 offen offset:3072 nt lds
    s_mov_b32 m0, 73728
    s_add_u32 s13, s12, 73728
    buffer_load_dwordx4 v8, s[40:43], s13 offen offset:0 nt lds
    buffer_load_dwordx4 v9, s[40:43], s13 offen offset:1024 nt lds
    buffer_load_dwordx4 v10, s[40:43], s13 offen offset:2048 nt lds
    buffer_load_dwordx4 v11, s[40:43], s13 offen offset:3072 nt lds
    s_mov_b32 m0, 77824
    s_add_u32 s13, s12, 77824
    buffer_load_dwordx4 v8, s[40:43], s13 offen offset:0 nt lds
    buffer_load_dwordx4 v9, s[40:43], s13 offen offset:1024 nt lds
    buffer_load_dwordx4 v10, s[40:43], s13 offen offset:2048 nt lds
    buffer_load_dwordx4 v11, s[40:43], s13 offen offset:3072 nt lds
    s_mov_b32 m0, 90112
    s_add_u32 s13, s15, 72
    buffer_load_dword v23, s[48:51], s13 offen lds
L_LW31:
    ds_read_b32 v21, v20
    s_waitcnt lgkmcnt(0)
    v_cmp_gt_u32 vcc, 11, v21
    s_cbranch_vccz L_LX32
    s_sleep 1
    s_add_u32 s84, s84, 1
    s_cmp_lt_u32 s84, 2097152
    s_cbranch_scc1 L_LW31
    s_endpgm
L_LX32:
    s_mov_b32 m0, 155648
    s_add_u32 s13, s12, 65536
    buffer_load_dwordx4 v8, s[44:47], s13 offen offset:0 nt lds
    buffer_load_dwordx4 v8, s[44:47], s13 offen offset:1024 nt lds
    buffer_load_dwordx4 v8, s[44:47], s13 offen offset:2048 nt lds
    buffer_load_dwordx4 v8, s[44:47], s13 offen offset:3072 nt lds
    s_mov_b32 m0, 159744
    s_add_u32 s13, s12, 69632
    buffer_load_dwordx4 v8, s[44:47], s13 offen offset:0 nt lds
    buffer_load_dwordx4 v8, s[44:47], s13 offen offset:1024 nt lds
    buffer_load_dwordx4 v8, s[44:47], s13 offen offset:2048 nt lds
    buffer_load_dwordx4 v8, s[44:47], s13 offen offset:3072 nt lds
    s_mov_b32 m0, 0
    s_add_u32 s13, s12, 81920
    buffer_load_dwordx4 v8, s[40:43], s13 offen offset:0 nt lds
    buffer_load_dwordx4 v9, s[40:43], s13 offen offset:1024 nt lds
    buffer_load_dwordx4 v10, s[40:43], s13 offen offset:2048 nt lds
    buffer_load_dwordx4 v11, s[40:43], s13 offen offset:3072 nt lds
    s_mov_b32 m0, 4096
    s_add_u32 s13, s12, 86016
    buffer_load_dwordx4 v8, s[40:43], s13 offen offset:0 nt lds
    buffer_load_dwordx4 v9, s[40:43], s13 offen offset:1024 nt lds
    buffer_load_dwordx4 v10, s[40:43], s13 offen offset:2048 nt lds
    buffer_load_dwordx4 v11, s[40:43], s13 offen offset:3072 nt lds
    s_mov_b32 m0, 90112
    s_add_u32 s13, s15, 76
    buffer_load_dword v23, s[48:51], s13 offen lds
L_LW33:
    ds_read_b32 v21, v20
    s_waitcnt lgkmcnt(0)
    v_cmp_gt_u32 vcc, 12, v21
    s_cbranch_vccz L_LX34
    s_sleep 1
    s_add_u32 s84, s84, 1
    s_cmp_lt_u32 s84, 2097152
    s_cbranch_scc1 L_LW33
    s_endpgm
L_LX34:
    s_mov_b32 m0, 147456
    s_add_u32 s13, s12, 73728
    buffer_load_dwordx4 v8, s[44:47], s13 offen offset:0 nt lds
    buffer_load_dwordx4 v8, s[44:47], s13 offen offset:1024 nt lds
    buffer_load_dwordx4 v8, s[44:47], s13 offen offset:2048 nt lds
    buffer_load_dwordx4 v8, s[44:47], s13 offen offset:3072 nt lds
    s_mov_b32 m0, 151552
    s_add_u32 s13, s12, 77824
    buffer_load_dwordx4 v8, s[44:47], s13 offen offset:0 nt lds
    buffer_load_dwordx4 v8, s[44:47], s13 offen offset:1024 nt lds
    buffer_load_dwordx4 v8, s[44:47], s13 offen offset:2048 nt lds
    buffer_load_dwordx4 v8, s[44:47], s13 offen offset:3072 nt lds
    s_mov_b32 m0, 8192
    s_add_u32 s13, s12, 90112
    buffer_load_dwordx4 v8, s[40:43], s13 offen offset:0 nt lds
    buffer_load_dwordx4 v9, s[40:43], s13 offen offset:1024 nt lds
    buffer_load_dwordx4 v10, s[40:43], s13 offen offset:2048 nt lds
    buffer_load_dwordx4 v11, s[40:43], s13 offen offset:3072 nt lds
    s_mov_b32 m0, 12288
    s_add_u32 s13, s12, 94208
    buffer_load_dwordx4 v8, s[40:43], s13 offen offset:0 nt lds
    buffer_load_dwordx4 v9, s[40:43], s13 offen offset:1024 nt lds
    buffer_load_dwordx4 v10, s[40:43], s13 offen offset:2048 nt lds
    buffer_load_dwordx4 v11, s[40:43], s13 offen offset:3072 nt lds
    s_mov_b32 m0, 90112
    s_add_u32 s13, s15, 80
    buffer_load_dword v23, s[48:51], s13 offen lds
L_LW35:
    ds_read_b32 v21, v20
    s_waitcnt lgkmcnt(0)
    v_cmp_gt_u32 vcc, 13, v21
    s_cbranch_vccz L_LX36
    s_sleep 1
    s_add_u32 s84, s84, 1
    s_cmp_lt_u32 s84, 2097152
    s_cbranch_scc1 L_LW35
    s_endpgm
L_LX36:
    s_mov_b32 m0, 139264
    s_add_u32 s13, s12, 81920
    buffer_load_dwordx4 v8, s[44:47], s13 offen offset:0 nt lds
    buffer_load_dwordx4 v8, s[44:47], s13 offen offset:1024 nt lds
    buffer_load_dwordx4 v8, s[44:47], s13 offen offset:2048 nt lds
    buffer_load_dwordx4 v8, s[44:47], s13 offen offset:3072 nt lds
    s_mov_b32 m0, 143360
    s_add_u32 s13, s12, 86016
    buffer_load_dwordx4 v8, s[44:47], s13 offen offset:0 nt lds
    buffer_load_dwordx4 v8, s[44:47], s13 offen offset:1024 nt lds
    buffer_load_dwordx4 v8, s[44:47], s13 offen offset:2048 nt lds
    buffer_load_dwordx4 v8, s[44:47], s13 offen offset:3072 nt lds
    s_mov_b32 m0, 16384
    s_add_u32 s13, s12, 98304
    buffer_load_dwordx4 v8, s[40:43], s13 offen offset:0 nt lds
    buffer_load_dwordx4 v9, s[40:43], s13 offen offset:1024 nt lds
    buffer_load_dwordx4 v10, s[40:43], s13 offen offset:2048 nt lds
    buffer_load_dwordx4 v11, s[40:43], s13 offen offset:3072 nt lds
    s_mov_b32 m0, 20480
    s_add_u32 s13, s12, 102400
    buffer_load_dwordx4 v8, s[40:43], s13 offen offset:0 nt lds
    buffer_load_dwordx4 v9, s[40:43], s13 offen offset:1024 nt lds
    buffer_load_dwordx4 v10, s[40:43], s13 offen offset:2048 nt lds
    buffer_load_dwordx4 v11, s[40:43], s13 offen offset:3072 nt lds
    s_mov_b32 m0, 90112
    s_add_u32 s13, s15, 84
    buffer_load_dword v23, s[48:51], s13 offen lds
    s_lshl_b32 s4, s92, 7
    s_add_u32 s4, s4, 34734080
    v_lshlrev_b32 v7, 2, v6
    buffer_load_dword v25, v7, s[48:51], s4 offen sc1
L_LW37:
    ds_read_b32 v21, v20
    s_waitcnt lgkmcnt(0)
    v_cmp_gt_u32 vcc, 14, v21
    s_cbranch_vccz L_LX38
    s_sleep 1
    s_add_u32 s84, s84, 1
    s_cmp_lt_u32 s84, 2097152
    s_cbranch_scc1 L_LW37
    s_endpgm
L_LX38:
    s_mov_b32 m0, 131072
    s_add_u32 s13, s12, 90112
    buffer_load_dwordx4 v8, s[44:47], s13 offen offset:0 nt lds
    buffer_load_dwordx4 v8, s[44:47], s13 offen offset:1024 nt lds
    buffer_load_dwordx4 v8, s[44:47], s13 offen offset:2048 nt lds
    buffer_load_dwordx4 v8, s[44:47], s13 offen offset:3072 nt lds
    s_mov_b32 m0, 135168
    s_add_u32 s13, s12, 94208
    buffer_load_dwordx4 v8, s[44:47], s13 offen offset:0 nt lds
    buffer_load_dwordx4 v8, s[44:47], s13 offen offset:1024 nt lds
    buffer_load_dwordx4 v8, s[44:47], s13 offen offset:2048 nt lds
    buffer_load_dwordx4 v8, s[44:47], s13 offen offset:3072 nt lds
    s_mov_b32 m0, 24576
    s_add_u32 s13, s12, 106496
    buffer_load_dwordx4 v8, s[40:43], s13 offen offset:0 nt lds
    buffer_load_dwordx4 v9, s[40:43], s13 offen offset:1024 nt lds
    buffer_load_dwordx4 v10, s[40:43], s13 offen offset:2048 nt lds
    buffer_load_dwordx4 v11, s[40:43], s13 offen offset:3072 nt lds
    s_mov_b32 m0, 28672
    s_add_u32 s13, s12, 110592
    buffer_load_dwordx4 v8, s[40:43], s13 offen offset:0 nt lds
    buffer_load_dwordx4 v9, s[40:43], s13 offen offset:1024 nt lds
    buffer_load_dwordx4 v10, s[40:43], s13 offen offset:2048 nt lds
    buffer_load_dwordx4 v11, s[40:43], s13 offen offset:3072 nt lds
    s_mov_b32 m0, 90112
    s_add_u32 s13, s15, 88
    buffer_load_dword v23, s[48:51], s13 offen lds
L_LW39:
    ds_read_b32 v21, v20
    s_waitcnt lgkmcnt(0)
    v_cmp_gt_u32 vcc, 15, v21
    s_cbranch_vccz L_LX40
    s_sleep 1
    s_add_u32 s84, s84, 1
    s_cmp_lt_u32 s84, 2097152
    s_cbranch_scc1 L_LW39
    s_endpgm
L_LX40:
    s_mov_b32 m0, 122880
    s_add_u32 s13, s12, 98304
    buffer_load_dwordx4 v8, s[44:47], s13 offen offset:0 nt lds
    buffer_load_dwordx4 v8, s[44:47], s13 offen offset:1024 nt lds
    buffer_load_dwordx4 v8, s[44:47], s13 offen offset:2048 nt lds
    buffer_load_dwordx4 v8, s[44:47], s13 offen offset:3072 nt lds
    s_mov_b32 m0, 126976
    s_add_u32 s13, s12, 102400
    buffer_load_dwordx4 v8, s[44:47], s13 offen offset:0 nt lds
    buffer_load_dwordx4 v8, s[44:47], s13 offen offset:1024 nt lds
    buffer_load_dwordx4 v8, s[44:47], s13 offen offset:2048 nt lds
    buffer_load_dwordx4 v8, s[44:47], s13 offen offset:3072 nt lds
    s_mov_b32 m0, 32768
    s_add_u32 s13, s12, 114688
    buffer_load_dwordx4 v8, s[40:43], s13 offen offset:0 nt lds
    buffer_load_dwordx4 v9, s[40:43], s13 offen offset:1024 nt lds
    buffer_load_dwordx4 v10, s[40:43], s13 offen offset:2048 nt lds
    buffer_load_dwordx4 v11, s[40:43], s13 offen offset:3072 nt lds
    s_mov_b32 m0, 36864
    s_add_u32 s13, s12, 118784
    buffer_load_dwordx4 v8, s[40:43], s13 offen offset:0 nt lds
    buffer_load_dwordx4 v9, s[40:43], s13 offen offset:1024 nt lds
    buffer_load_dwordx4 v10, s[40:43], s13 offen offset:2048 nt lds
    buffer_load_dwordx4 v11, s[40:43], s13 offen offset:3072 nt lds
    s_mov_b32 m0, 90112
    s_add_u32 s13, s15, 92
    buffer_load_dword v23, s[48:51], s13 offen lds
    s_waitcnt vmcnt(32)
    v_cmp_ne_u32 vcc, v24, v25
    s_nop 0
    s_cmp_eq_u64 vcc, 0
    s_cselect_b32 s5, 2, 1
    v_or_b32 v29, s5, v38
    ds_write_b32 v33, v29 offset:2048
L_LW41:
    ds_read_b32 v21, v20
    s_waitcnt lgkmcnt(0)
    v_cmp_gt_u32 vcc, 16, v21
    s_cbranch_vccz L_LX42
    s_sleep 1
    s_add_u32 s84, s84, 1
    s_cmp_lt_u32 s84, 2097152
    s_cbranch_scc1 L_LW41
    s_endpgm
L_LX42:
    s_mov_b32 m0, 114688
    s_add_u32 s13, s12, 106496
    buffer_load_dwordx4 v8, s[44:47], s13 offen offset:0 nt lds
    buffer_load_dwordx4 v8, s[44:47], s13 offen offset:1024 nt lds
    buffer_load_dwordx4 v8, s[44:47], s13 offen offset:2048 nt lds
    buffer_load_dwordx4 v8, s[44:47], s13 offen offset:3072 nt lds
    s_mov_b32 m0, 118784
    s_add_u32 s13, s12, 110592
    buffer_load_dwordx4 v8, s[44:47], s13 offen offset:0 nt lds
    buffer_load_dwordx4 v8, s[44:47], s13 offen offset:1024 nt lds
    buffer_load_dwordx4 v8, s[44:47], s13 offen offset:2048 nt lds
    buffer_load_dwordx4 v8, s[44:47], s13 offen offset:3072 nt lds
    s_mov_b32 m0, 40960
    s_add_u32 s13, s12, 122880
    buffer_load_dwordx4 v8, s[40:43], s13 offen offset:0 nt lds
    buffer_load_dwordx4 v9, s[40:43], s13 offen offset:1024 nt lds
    buffer_load_dwordx4 v10, s[40:43], s13 offen offset:2048 nt lds
    buffer_load_dwordx4 v11, s[40:43], s13 offen offset:3072 nt lds
    s_mov_b32 m0, 45056
    s_add_u32 s13, s12, 126976
    buffer_load_dwordx4 v8, s[40:43], s13 offen offset:0 nt lds
    buffer_load_dwordx4 v9, s[40:43], s13 offen offset:1024 nt lds
    buffer_load_dwordx4 v10, s[40:43], s13 offen offset:2048 nt lds
    buffer_load_dwordx4 v11, s[40:43], s13 offen offset:3072 nt lds
    s_mov_b32 m0, 90112
    s_add_u32 s13, s15, 96
    buffer_load_dword v23, s[48:51], s13 offen lds
L_LW43:
    ds_read_b32 v21, v20
    s_waitcnt lgkmcnt(0)
    v_cmp_gt_u32 vcc, 17, v21
    s_cbranch_vccz L_LX44
    s_sleep 1
    s_add_u32 s84, s84, 1
    s_cmp_lt_u32 s84, 2097152
    s_cbranch_scc1 L_LW43
    s_endpgm
L_LX44:
    s_mov_b32 m0, 106496
    s_add_u32 s13, s12, 114688
    buffer_load_dwordx4 v8, s[44:47], s13 offen offset:0 nt lds
    buffer_load_dwordx4 v8, s[44:47], s13 offen offset:1024 nt lds
    buffer_load_dwordx4 v8, s[44:47], s13 offen offset:2048 nt lds
    buffer_load_dwordx4 v8, s[44:47], s13 offen offset:3072 nt lds
    s_mov_b32 m0, 110592
    s_add_u32 s13, s12, 118784
    buffer_load_dwordx4 v8, s[44:47], s13 offen offset:0 nt lds
    buffer_load_dwordx4 v8, s[44:47], s13 offen offset:1024 nt lds
    buffer_load_dwordx4 v8, s[44:47], s13 offen offset:2048 nt lds
    buffer_load_dwordx4 v8, s[44:47], s13 offen offset:3072 nt lds
    s_mov_b32 m0, 90112
    s_add_u32 s13, s15, 100
    buffer_load_dword v23, s[48:51], s13 offen lds
L_LW45:
    ds_read_b32 v21, v20
    s_waitcnt lgkmcnt(0)
    v_cmp_gt_u32 vcc, 18, v21
    s_cbranch_vccz L_LX46
    s_sleep 1
    s_add_u32 s84, s84, 1
    s_cmp_lt_u32 s84, 2097152
    s_cbranch_scc1 L_LW45
    s_endpgm
L_LX46:
    s_mov_b32 m0, 98304
    s_add_u32 s13, s12, 122880
    buffer_load_dwordx4 v8, s[44:47], s13 offen offset:0 nt lds
    buffer_load_dwordx4 v8, s[44:47], s13 offen offset:1024 nt lds
    buffer_load_dwordx4 v8, s[44:47], s13 offen offset:2048 nt lds
    buffer_load_dwordx4 v8, s[44:47], s13 offen offset:3072 nt lds
    s_mov_b32 m0, 102400
    s_add_u32 s13, s12, 126976
    buffer_load_dwordx4 v8, s[44:47], s13 offen offset:0 nt lds
    buffer_load_dwordx4 v8, s[44:47], s13 offen offset:1024 nt lds
    buffer_load_dwordx4 v8, s[44:47], s13 offen offset:2048 nt lds
    buffer_load_dwordx4 v8, s[44:47], s13 offen offset:3072 nt lds
    s_mov_b32 m0, 90112
    s_add_u32 s13, s15, 104
    buffer_load_dword v23, s[48:51], s13 offen lds
    s_mul_i32 s6, s92, 28
    s_and_b32 s7, s8, 3
    s_mul_i32 s7, s7, 7
    s_add_u32 s6, s6, s7
    s_lshl_b32 s6, s6, 16
    s_and_b32 s7, s9, 7
    s_lshl_b32 s7, s7, 2
    s_lshl_b32 s7, s7, 11
    s_add_u32 s6, s6, s7
    v_lshlrev_b32 v7, 7, v0
    s_waitcnt vmcnt(63)
    s_add_u32 s13, s6, 0
    buffer_load_dword v40, v7, s[48:51], s13 offen sc1 nt
    buffer_load_dword v41, v7, s[48:51], s13 offen sc1
    s_waitcnt vmcnt(63)
    s_add_u32 s13, s6, 65536
    buffer_load_dword v40, v7, s[48:51], s13 offen sc1 nt
    buffer_load_dword v41, v7, s[48:51], s13 offen sc1
    s_waitcnt vmcnt(63)
    s_add_u32 s13, s6, 131072
    buffer_load_dword v40, v7, s[48:51], s13 offen sc1 nt
    buffer_load_dword v41, v7, s[48:51], s13 offen sc1
    s_waitcnt vmcnt(63)
    s_add_u32 s13, s6, 196608
    buffer_load_dword v40, v7, s[48:51], s13 offen sc1 nt
    buffer_load_dword v41, v7, s[48:51], s13 offen sc1
    s_waitcnt vmcnt(63)
    s_add_u32 s13, s6, 262144
    buffer_load_dword v40, v7, s[48:51], s13 offen sc1 nt
    buffer_load_dword v41, v7, s[48:51], s13 offen sc1
    s_waitcnt vmcnt(63)
    s_add_u32 s13, s6, 327680
    buffer_load_dword v40, v7, s[48:51], s13 offen sc1 nt
    buffer_load_dword v41, v7, s[48:51], s13 offen sc1
    s_waitcnt vmcnt(63)
    s_add_u32 s13, s6, 393216
    buffer_load_dword v40, v7, s[48:51], s13 offen sc1 nt
    buffer_load_dword v41, v7, s[48:51], s13 offen sc1
    s_mul_i32 s4, s93, 1179648
    s_mul_i32 s5, s94, 36864
    s_add_u32 s4, s4, s5
    v_lshlrev_b32 v7, 7, v0
    s_waitcnt vmcnt(63)
    s_add_u32 s5, s4, 0
    buffer_load_dword v41, v7, s[52:55], s5 offen sc1
    s_mul_i32 s4, s93, 1179648
    s_mul_i32 s5, s94, 36864
    s_add_u32 s4, s4, s5
    v_lshlrev_b32 v7, 7, v0
    s_waitcnt vmcnt(63)
    s_add_u32 s5, s4, 8192
    buffer_load_dword v41, v7, s[52:55], s5 offen sc1
    s_mul_i32 s4, s93, 1179648
    s_mul_i32 s5, s94, 36864
    s_add_u32 s4, s4, s5
    v_lshlrev_b32 v7, 7, v0
    s_waitcnt vmcnt(63)
    s_add_u32 s5, s4, 16384
    buffer_load_dword v41, v7, s[52:55], s5 offen sc1
    s_mul_i32 s4, s93, 1179648
    s_mul_i32 s5, s94, 36864
    s_add_u32 s4, s4, s5
    v_lshlrev_b32 v7, 7, v0
    s_waitcnt vmcnt(63)
    s_add_u32 s5, s4, 24576
    buffer_load_dword v41, v7, s[52:55], s5 offen sc1
    s_mul_i32 s4, s93, 1179648
    s_mul_i32 s5, s94, 36864
    s_add_u32 s4, s4, s5
    v_lshlrev_b32 v7, 7, v0
    v_min_u32 v7, 3968, v7
    s_waitcnt vmcnt(63)
    s_add_u32 s5, s4, 32768
    buffer_load_dword v41, v7, s[52:55], s5 offen sc1
    s_mul_i32 s85, s93, 1179648
    s_add_u32 s85, s85, s97
    s_mul_i32 s14, s92, 28
    s_add_u32 s14, s14, s96
    s_lshl_b32 s86, s14, 16
    s_lshl_b32 s14, s14, 7
    s_add_u32 s14, s14, 34603008
    s_movk_i32 s5, 1152
    s_cmp_ge_u32 s94, 28
    s_cbranch_scc1 L_L2
    v_mul_lo_u32 v7, v3, s5
    v_lshl_add_u32 v29, v4, 2, v2
    v_lshl_add_u32 v16, v29, 4, v7
    v_add_u32 v17, 3584, v16
    v_add_u32 v18, 7168, v16
    v_add_u32 v19, 10752, v16
    s_mov_b32 s87, 49152
    s_mov_b32 s88, 98304
    s_mov_b32 s6, 16
L_PRE47:
L_LW48:
    ds_read_b32 v21, v20
    s_waitcnt lgkmcnt(0)
    v_cmp_gt_u32 vcc, s6, v21
    s_cbranch_vccz L_LX49
    s_sleep 1
    s_add_u32 s84, s84, 1
    s_cmp_lt_u32 s84, 2097152
    s_cbranch_scc1 L_LW48
    s_endpgm
L_LX49:
    s_waitcnt vmcnt(12)
    s_add_u32 m0, s87, 0
    s_add_u32 s13, s85, 0
    buffer_load_dwordx4 v16, s[52:55], s13 offen offset:0 lds
    buffer_load_dwordx4 v17, s[52:55], s13 offen offset:1024 lds
    buffer_load_dwordx4 v18, s[52:55], s13 offen offset:2048 lds
    buffer_load_dwordx4 v19, s[52:55], s13 offen offset:3072 lds
    s_add_u32 m0, s87, 4096
    s_add_u32 s13, s85, 18432
    buffer_load_dwordx4 v16, s[52:55], s13 offen offset:0 lds
    buffer_load_dwordx4 v17, s[52:55], s13 offen offset:1024 lds
    buffer_load_dwordx4 v18, s[52:55], s13 offen offset:2048 lds
    buffer_load_dwordx4 v19, s[52:55], s13 offen offset:3072 lds
    s_add_u32 m0, s87, 8192
    s_add_u32 s13, s85, 36864
    buffer_load_dwordx4 v16, s[52:55], s13 offen offset:0 lds
    buffer_load_dwordx4 v17, s[52:55], s13 offen offset:1024 lds
    buffer_load_dwordx4 v18, s[52:55], s13 offen offset:2048 lds
    buffer_load_dwordx4 v19, s[52:55], s13 offen offset:3072 lds
    s_add_u32 m0, s87, 12288
    s_add_u32 s13, s85, 55296
    buffer_load_dwordx4 v16, s[52:55], s13 offen offset:0 lds
    buffer_load_dwordx4 v17, s[52:55], s13 offen offset:1024 lds
    buffer_load_dwordx4 v18, s[52:55], s13 offen offset:2048 lds
    buffer_load_dwordx4 v19, s[52:55], s13 offen offset:3072 lds
    s_add_u32 s85, s85, 73728
    s_add_u32 s87, s87, 16384
    s_cmp_eq_u32 s87, 81920
    s_cselect_b32 s87, 0, s87
    s_add_u32 s6, s6, 2
    s_cmp_le_u32 s6, 24
    s_cbranch_scc1 L_PRE47
L_LW50:
    ds_read_b32 v21, v20
    s_waitcnt lgkmcnt(0)
    v_cmp_gt_u32 vcc, 26, v21
    s_cbranch_vccz L_LX51
    s_sleep 1
    s_add_u32 s84, s84, 1
    s_cmp_lt_u32 s84, 2097152
    s_cbranch_scc1 L_LW50
    s_endpgm
L_LX51:
    v_lshrrev_b32 v7, 3, v0
    v_min_u32 v7, 3, v7
    v_lshlrev_b32 v7, 7, v7
    v_and_b32 v29, 7, v0
    v_lshl_add_u32 v7, v29, 2, v7
L_OF52:
    buffer_load_dword v29, v7, s[48:51], s14 offen sc1
    s_waitcnt vmcnt(0)
    v_cmp_ne_u32 vcc, v38, v29
    s_cbranch_vccz L_OG53
    s_sleep 1
    s_add_u32 s84, s84, 1
    s_cmp_lt_u32 s84, 2097152
    s_cbranch_scc1 L_OF52
    s_endpgm
L_OG53:
    s_mov_b32 s10, 27
L_O054:
    s_add_u32 m0, s88, 0
    s_add_u32 s13, s86, 0
    buffer_load_dwordx4 v36, s[48:51], s13 offen offset:0 sc1 lds
    buffer_load_dwordx4 v36, s[48:51], s13 offen offset:1024 sc1 lds
    buffer_load_dwordx4 v36, s[48:51], s13 offen offset:2048 sc1 lds
    buffer_load_dwordx4 v36, s[48:51], s13 offen offset:3072 sc1 lds
    s_add_u32 m0, s88, 4096
    s_add_u32 s13, s86, 65536
    buffer_load_dwordx4 v36, s[48:51], s13 offen offset:0 sc1 lds
    buffer_load_dwordx4 v36, s[48:51], s13 offen offset:1024 sc1 lds
    buffer_load_dwordx4 v36, s[48:51], s13 offen offset:2048 sc1 lds
    buffer_load_dwordx4 v36, s[48:51], s13 offen offset:3072 sc1 lds
    s_add_u32 m0, s88, 8192
    s_add_u32 s13, s86, 131072
    buffer_load_dwordx4 v36, s[48:51], s13 offen offset:0 sc1 lds
    buffer_load_dwordx4 v36, s[48:51], s13 offen offset:1024 sc1 lds
    buffer_load_dwordx4 v36, s[48:51], s13 offen offset:2048 sc1 lds
    buffer_load_dwordx4 v36, s[48:51], s13 offen offset:3072 sc1 lds
    s_add_u32 m0, s88, 12288
    s_add_u32 s13, s86, 196608
    buffer_load_dwordx4 v36, s[48:51], s13 offen offset:0 sc1 lds
    buffer_load_dwordx4 v36, s[48:51], s13 offen offset:1024 sc1 lds
    buffer_load_dwordx4 v36, s[48:51], s13 offen offset:2048 sc1 lds
    buffer_load_dwordx4 v36, s[48:51], s13 offen offset:3072 sc1 lds
    s_add_u32 s86, s86, 4096
    s_add_u32 s88, s88, 16384
    s_cmp_eq_u32 s88, 163840
    s_cselect_b32 s88, 98304, s88
    s_mov_b32 m0, 90112
    s_lshl_b32 s13, s10, 2
    s_add_u32 s13, s13, s15
    buffer_load_dword v23, s[48:51], s13 offen lds
    s_add_u32 s10, s10, 1
    s_cmp_lt_u32 s10, 31
    s_cbranch_scc1 L_O054
    s_mov_b32 s6, 0
L_OM55:
    s_barrier
    s_cmp_ge_u32 s6, 12
    s_cbranch_scc1 L_OA56
    s_add_u32 m0, s88, 0
    s_add_u32 s13, s86, 0
    buffer_load_dwordx4 v36, s[48:51], s13 offen offset:0 sc1 lds
    buffer_load_dwordx4 v36, s[48:51], s13 offen offset:1024 sc1 lds
    buffer_load_dwordx4 v36, s[48:51], s13 offen offset:2048 sc1 lds
    buffer_load_dwordx4 v36, s[48:51], s13 offen offset:3072 sc1 lds
    s_add_u32 m0, s88, 4096
    s_add_u32 s13, s86, 65536
    buffer_load_dwordx4 v36, s[48:51], s13 offen offset:0 sc1 lds
    buffer_load_dwordx4 v36, s[48:51], s13 offen offset:1024 sc1 lds
    buffer_load_dwordx4 v36, s[48:51], s13 offen offset:2048 sc1 lds
    buffer_load_dwordx4 v36, s[48:51], s13 offen offset:3072 sc1 lds
    s_add_u32 m0, s88, 8192
    s_add_u32 s13, s86, 131072
    buffer_load_dwordx4 v36, s[48:51], s13 offen offset:0 sc1 lds
    buffer_load_dwordx4 v36, s[48:51], s13 offen offset:1024 sc1 lds
    buffer_load_dwordx4 v36, s[48:51], s13 offen offset:2048 sc1 lds
    buffer_load_dwordx4 v36, s[48:51], s13 offen offset:3072 sc1 lds
    s_add_u32 m0, s88, 12288
    s_add_u32 s13, s86, 196608
    buffer_load_dwordx4 v36, s[48:51], s13 offen offset:0 sc1 lds
    buffer_load_dwordx4 v36, s[48:51], s13 offen offset:1024 sc1 lds
    buffer_load_dwordx4 v36, s[48:51], s13 offen offset:2048 sc1 lds
    buffer_load_dwordx4 v36, s[48:51], s13 offen offset:3072 sc1 lds
    s_add_u32 s86, s86, 4096
    s_add_u32 s88, s88, 16384
    s_cmp_eq_u32 s88, 163840
    s_cselect_b32 s88, 98304, s88
    s_mov_b32 m0, 90112
    s_lshl_b32 s13, s10, 2
    s_add_u32 s13, s13, s15
    buffer_load_dword v23, s[48:51], s13 offen lds
    s_add_u32 s10, s10, 1
L_OA56:
    s_cmp_ge_u32 s6, 11
    s_cbranch_scc1 L_OB57
    s_add_u32 m0, s87, 0
    s_add_u32 s13, s85, 0
    buffer_load_dwordx4 v16, s[52:55], s13 offen offset:0 lds
    buffer_load_dwordx4 v17, s[52:55], s13 offen offset:1024 lds
    buffer_load_dwordx4 v18, s[52:55], s13 offen offset:2048 lds
    buffer_load_dwordx4 v19, s[52:55], s13 offen offset:3072 lds
    s_add_u32 m0, s87, 4096
    s_add_u32 s13, s85, 18432
    buffer_load_dwordx4 v16, s[52:55], s13 offen offset:0 lds
    buffer_load_dwordx4 v17, s[52:55], s13 offen offset:1024 lds
    buffer_load_dwordx4 v18, s[52:55], s13 offen offset:2048 lds
    buffer_load_dwordx4 v19, s[52:55], s13 offen offset:3072 lds
    s_add_u32 m0, s87, 8192
    s_add_u32 s13, s85, 36864
    buffer_load_dwordx4 v16, s[52:55], s13 offen offset:0 lds
    buffer_load_dwordx4 v17, s[52:55], s13 offen offset:1024 lds
    buffer_load_dwordx4 v18, s[52:55], s13 offen offset:2048 lds
    buffer_load_dwordx4 v19, s[52:55], s13 offen offset:3072 lds
    s_add_u32 m0, s87, 12288
    s_add_u32 s13, s85, 55296
    buffer_load_dwordx4 v16, s[52:55], s13 offen offset:0 lds
    buffer_load_dwordx4 v17, s[52:55], s13 offen offset:1024 lds
    buffer_load_dwordx4 v18, s[52:55], s13 offen offset:2048 lds
    buffer_load_dwordx4 v19, s[52:55], s13 offen offset:3072 lds
    s_add_u32 s85, s85, 73728
    s_add_u32 s87, s87, 16384
    s_cmp_eq_u32 s87, 81920
    s_cselect_b32 s87, 0, s87
L_OB57:
    s_add_u32 s6, s6, 1
    s_cmp_lt_u32 s6, 16
    s_cbranch_scc1 L_OM55
    s_branch L_FINAL
L_L2:
    v_lshl_add_u32 v7, v5, 2, v3
    v_mul_lo_u32 v7, v7, s5
    v_and_b32 v29, 1, v4
    v_lshl_add_u32 v29, v29, 2, v2
    v_lshl_add_u32 v16, v29, 4, v7
    v_add_u32 v17, 8192, v16
    v_add_u32 v18, 16384, v16
    v_add_u32 v19, 24576, v16
    s_mov_b32 s87, 155648
    s_mov_b32 s88, 0
    s_mov_b32 s6, 19
L_PRE58:
L_LW59:
    ds_read_b32 v21, v20
    s_waitcnt lgkmcnt(0)
    v_cmp_gt_u32 vcc, s6, v21
    s_cbranch_vccz L_LX60
    s_sleep 1
    s_add_u32 s84, s84, 1
    s_cmp_lt_u32 s84, 2097152
    s_cbranch_scc1 L_LW59
    s_endpgm
L_LX60:
    s_waitcnt vmcnt(12)
    s_add_u32 m0, s87, 0
    s_add_u32 s13, s85, 0
    buffer_load_dwordx4 v16, s[52:55], s13 offen offset:0 lds
    buffer_load_dwordx4 v17, s[52:55], s13 offen offset:1024 lds
    buffer_load_dwordx4 v18, s[52:55], s13 offen offset:2048 lds
    buffer_load_dwordx4 v19, s[52:55], s13 offen offset:3072 lds
    s_add_u32 m0, s87, 4096
    s_add_u32 s13, s85, 36864
    buffer_load_dwordx4 v16, s[52:55], s13 offen offset:0 lds
    buffer_load_dwordx4 v17, s[52:55], s13 offen offset:1024 lds
    buffer_load_dwordx4 v18, s[52:55], s13 offen offset:2048 lds
    buffer_load_dwordx4 v19, s[52:55], s13 offen offset:3072 lds
    s_add_u32 s85, s85, 73728
    s_sub_u32 s87, s87, 8192
    s_cmp_eq_u32 s87, 90112
    s_cselect_b32 s87, 155648, s87
    s_add_u32 s6, s6, 1
    s_cmp_le_u32 s6, 26
    s_cbranch_scc1 L_PRE58
L_LW61:
    ds_read_b32 v21, v20
    s_waitcnt lgkmcnt(0)
    v_cmp_gt_u32 vcc, 26, v21
    s_cbranch_vccz L_LX62
    s_sleep 1
    s_add_u32 s84, s84, 1
    s_cmp_lt_u32 s84, 2097152
    s_cbranch_scc1 L_LW61
    s_endpgm
L_LX62:
    v_lshrrev_b32 v7, 3, v0
    v_min_u32 v7, 6, v7
    v_lshlrev_b32 v7, 7, v7
    v_and_b32 v29, 7, v0
    v_lshl_add_u32 v7, v29, 2, v7
L_OF63:
    buffer_load_dword v29, v7, s[48:51], s14 offen sc1
    s_waitcnt vmcnt(0)
    v_cmp_ne_u32 vcc, v38, v29
    s_cbranch_vccz L_OG64
    s_sleep 1
    s_add_u32 s84, s84, 1
    s_cmp_lt_u32 s84, 2097152
    s_cbranch_scc1 L_OF63
    s_endpgm
L_OG64:
    s_mov_b32 s10, 27
L_O065:
    s_add_u32 m0, s88, 0
    s_add_u32 s13, s86, 0
    buffer_load_dwordx4 v36, s[48:51], s13 offen offset:0 sc1 lds
    buffer_load_dwordx4 v36, s[48:51], s13 offen offset:1024 sc1 lds
    buffer_load_dwordx4 v36, s[48:51], s13 offen offset:2048 sc1 lds
    buffer_load_dwordx4 v36, s[48:51], s13 offen offset:3072 sc1 lds
    s_add_u32 m0, s88, 4096
    s_add_u32 s13, s86, 65536
    buffer_load_dwordx4 v36, s[48:51], s13 offen offset:0 sc1 lds
    buffer_load_dwordx4 v36, s[48:51], s13 offen offset:1024 sc1 lds
    buffer_load_dwordx4 v36, s[48:51], s13 offen offset:2048 sc1 lds
    buffer_load_dwordx4 v36, s[48:51], s13 offen offset:3072 sc1 lds
    s_add_u32 m0, s88, 8192
    s_add_u32 s13, s86, 131072
    buffer_load_dwordx4 v36, s[48:51], s13 offen offset:0 sc1 lds
    buffer_load_dwordx4 v36, s[48:51], s13 offen offset:1024 sc1 lds
    buffer_load_dwordx4 v36, s[48:51], s13 offen offset:2048 sc1 lds
    buffer_load_dwordx4 v36, s[48:51], s13 offen offset:3072 sc1 lds
    s_add_u32 m0, s88, 12288
    s_add_u32 s13, s86, 196608
    buffer_load_dwordx4 v36, s[48:51], s13 offen offset:0 sc1 lds
    buffer_load_dwordx4 v36, s[48:51], s13 offen offset:1024 sc1 lds
    buffer_load_dwordx4 v36, s[48:51], s13 offen offset:2048 sc1 lds
    buffer_load_dwordx4 v36, s[48:51], s13 offen offset:3072 sc1 lds
    s_add_u32 m0, s88, 16384
    s_add_u32 s13, s86, 262144
    buffer_load_dwordx4 v36, s[48:51], s13 offen offset:0 sc1 lds
    buffer_load_dwordx4 v36, s[48:51], s13 offen offset:1024 sc1 lds
    buffer_load_dwordx4 v36, s[48:51], s13 offen offset:2048 sc1 lds
    buffer_load_dwordx4 v36, s[48:51], s13 offen offset:3072 sc1 lds
    s_add_u32 m0, s88, 20480
    s_add_u32 s13, s86, 327680
    buffer_load_dwordx4 v36, s[48:51], s13 offen offset:0 sc1 lds
    buffer_load_dwordx4 v36, s[48:51], s13 offen offset:1024 sc1 lds
    buffer_load_dwordx4 v36, s[48:51], s13 offen offset:2048 sc1 lds
    buffer_load_dwordx4 v36, s[48:51], s13 offen offset:3072 sc1 lds
    s_add_u32 m0, s88, 24576
    s_add_u32 s13, s86, 393216
    buffer_load_dwordx4 v36, s[48:51], s13 offen offset:0 sc1 lds
    buffer_load_dwordx4 v36, s[48:51], s13 offen offset:1024 sc1 lds
    buffer_load_dwordx4 v36, s[48:51], s13 offen offset:2048 sc1 lds
    buffer_load_dwordx4 v36, s[48:51], s13 offen offset:3072 sc1 lds
    s_add_u32 s86, s86, 4096
    s_add_u32 s88, s88, 28672
    s_cmp_eq_u32 s88, 86016
    s_cselect_b32 s88, 0, s88
    s_mov_b32 m0, 90112
    s_lshl_b32 s13, s10, 2
    s_add_u32 s13, s13, s15
    buffer_load_dword v23, s[48:51], s13 offen lds
    s_add_u32 s10, s10, 1
    s_cmp_lt_u32 s10, 30
    s_cbranch_scc1 L_O065
    s_mov_b32 s6, 0
L_OM66:
    s_barrier
    s_cmp_ge_u32 s6, 13
    s_cbranch_scc1 L_OA67
    s_add_u32 m0, s88, 0
    s_add_u32 s13, s86, 0
    buffer_load_dwordx4 v36, s[48:51], s13 offen offset:0 sc1 lds
    buffer_load_dwordx4 v36, s[48:51], s13 offen offset:1024 sc1 lds
    buffer_load_dwordx4 v36, s[48:51], s13 offen offset:2048 sc1 lds
    buffer_load_dwordx4 v36, s[48:51], s13 offen offset:3072 sc1 lds
    s_add_u32 m0, s88, 4096
    s_add_u32 s13, s86, 65536
    buffer_load_dwordx4 v36, s[48:51], s13 offen offset:0 sc1 lds
    buffer_load_dwordx4 v36, s[48:51], s13 offen offset:1024 sc1 lds
    buffer_load_dwordx4 v36, s[48:51], s13 offen offset:2048 sc1 lds
    buffer_load_dwordx4 v36, s[48:51], s13 offen offset:3072 sc1 lds
    s_add_u32 m0, s88, 8192
    s_add_u32 s13, s86, 131072
    buffer_load_dwordx4 v36, s[48:51], s13 offen offset:0 sc1 lds
    buffer_load_dwordx4 v36, s[48:51], s13 offen offset:1024 sc1 lds
    buffer_load_dwordx4 v36, s[48:51], s13 offen offset:2048 sc1 lds
    buffer_load_dwordx4 v36, s[48:51], s13 offen offset:3072 sc1 lds
    s_add_u32 m0, s88, 12288
    s_add_u32 s13, s86, 196608
    buffer_load_dwordx4 v36, s[48:51], s13 offen offset:0 sc1 lds
    buffer_load_dwordx4 v36, s[48:51], s13 offen offset:1024 sc1 lds
    buffer_load_dwordx4 v36, s[48:51], s13 offen offset:2048 sc1 lds
    buffer_load_dwordx4 v36, s[48:51], s13 offen offset:3072 sc1 lds
    s_add_u32 m0, s88, 16384
    s_add_u32 s13, s86, 262144
    buffer_load_dwordx4 v36, s[48:51], s13 offen offset:0 sc1 lds
    buffer_load_dwordx4 v36, s[48:51], s13 offen offset:1024 sc1 lds
    buffer_load_dwordx4 v36, s[48:51], s13 offen offset:2048 sc1 lds
    buffer_load_dwordx4 v36, s[48:51], s13 offen offset:3072 sc1 lds
    s_add_u32 m0, s88, 20480
    s_add_u32 s13, s86, 327680
    buffer_load_dwordx4 v36, s[48:51], s13 offen offset:0 sc1 lds
    buffer_load_dwordx4 v36, s[48:51], s13 offen offset:1024 sc1 lds
    buffer_load_dwordx4 v36, s[48:51], s13 offen offset:2048 sc1 lds
    buffer_load_dwordx4 v36, s[48:51], s13 offen offset:3072 sc1 lds
    s_add_u32 m0, s88, 24576
    s_add_u32 s13, s86, 393216
    buffer_load_dwordx4 v36, s[48:51], s13 offen offset:0 sc1 lds
    buffer_load_dwordx4 v36, s[48:51], s13 offen offset:1024 sc1 lds
    buffer_load_dwordx4 v36, s[48:51], s13 offen offset:2048 sc1 lds
    buffer_load_dwordx4 v36, s[48:51], s13 offen offset:3072 sc1 lds
    s_add_u32 s86, s86, 4096
    s_add_u32 s88, s88, 28672
    s_cmp_eq_u32 s88, 86016
    s_cselect_b32 s88, 0, s88
    s_mov_b32 m0, 90112
    s_lshl_b32 s13, s10, 2
    s_add_u32 s13, s13, s15
    buffer_load_dword v23, s[48:51], s13 offen lds
    s_add_u32 s10, s10, 1
L_OA67:
    s_cmp_ge_u32 s6, 8
    s_cbranch_scc1 L_OB68
    s_add_u32 m0, s87, 0
    s_add_u32 s13, s85, 0
    buffer_load_dwordx4 v16, s[52:55], s13 offen offset:0 lds
    buffer_load_dwordx4 v17, s[52:55], s13 offen offset:1024 lds
    buffer_load_dwordx4 v18, s[52:55], s13 offen offset:2048 lds
    buffer_load_dwordx4 v19, s[52:55], s13 offen offset:3072 lds
    s_add_u32 m0, s87, 4096
    s_add_u32 s13, s85, 36864
    buffer_load_dwordx4 v16, s[52:55], s13 offen offset:0 lds
    buffer_load_dwordx4 v17, s[52:55], s13 offen offset:1024 lds
    buffer_load_dwordx4 v18, s[52:55], s13 offen offset:2048 lds
    buffer_load_dwordx4 v19, s[52:55], s13 offen offset:3072 lds
    s_add_u32 s85, s85, 73728
    s_sub_u32 s87, s87, 8192
    s_cmp_eq_u32 s87, 90112
    s_cselect_b32 s87, 155648, s87
L_OB68:
    s_add_u32 s6, s6, 1
    s_cmp_lt_u32 s6, 16
    s_cbranch_scc1 L_OM66
    s_branch L_FINAL
L_END:
    s_endpgm
.p2align 4
L_CODE_END:
.section .rodata,"a"
.p2align 6
.amdhsa_kernel standalone__mha_block_cached__near_ridge_kernel
  .amdhsa_next_free_vgpr 256
  .amdhsa_next_free_sgpr 102
  .amdhsa_accum_offset 256
  .amdhsa_group_segment_fixed_size 0
  .amdhsa_kernarg_size 64
  .amdhsa_user_sgpr_count 2
  .amdhsa_user_sgpr_kernarg_segment_ptr 1
  .amdhsa_system_sgpr_workgroup_id_x 1
.end_amdhsa_kernel
```
